```python
import torch

def _softmax(x, axis=-1):
    return torch.softmax(x, dim=axis)
def _gelu(x):
    return torch.nn.functional.gelu(x, approximate="tanh")
def _silu(x):
    return torch.nn.functional.silu(x)
def _sigmoid(x):
    return torch.sigmoid(x)
def _layernorm(x, axis=-1, eps=1e-5):
    m = x.mean(dim=axis, keepdim=True)
    v = x.var(dim=axis, keepdim=True, unbiased=False)
    return (x - m) / torch.sqrt(v + eps)
def _scatter_add(tgt, idx, src, axis=0):
    return tgt.clone().index_add_(axis, idx, src)
def _segment_sum(src, seg, n):
    out = torch.zeros((n,) + src.shape[1:], dtype=src.dtype)
    return out.index_add_(0, seg, src)
def _pad(x, pw):
    flat = tuple(v for pair in reversed(pw) for v in pair)
    return torch.nn.functional.pad(x, flat)

kernel_name = 'recurrent_scan__sliding_block_cached__mixer_channel_mlp__decode'

def setup_inputs():

    _w = (lambda a: (lambda t: t.to(torch.bfloat16) if t.is_floating_point() else t)(torch.as_tensor(a)))
    def _A_setup():
        B, Sq, D = 1, 1, 512
        Hq, Hkv, Sk, Dh = 32, 32, 32768, 128
        assert Hq % Hkv == 0, (Hq, Hkv)
        return {
            "x": _w((lambda *s: torch.randn(*s, dtype=torch.bfloat16) * 0.1)(B, Sq, D)),
            "k_cache": _w((lambda *s: torch.randn(*s, dtype=torch.bfloat16) * 0.8)(B, Hkv, Sk, Dh)),
            "v_cache": _w((lambda *s: torch.randn(*s, dtype=torch.bfloat16) * 3.2)(B, Hkv, Sk, Dh)),
            "wq": _w((lambda *s: torch.randn(*s, dtype=torch.bfloat16) * 0.8)(D, Hq * Dh) * (D ** -0.5)),
            "wo": _w((lambda *s: torch.randn(*s, dtype=torch.bfloat16) * 3.2)(Hq * Dh, D) * ((Hq * Dh) ** -0.5)),
        }
    _A_in = _A_setup()

    def _B_setup():
        B, S, D, F = 1, 1, 512, 1376
        return {
            "x": _w((lambda *s: torch.randn(*s, dtype=torch.bfloat16) * 0.1)(B, S, D)),
            "w1": _w((lambda *s: torch.randn(*s, dtype=torch.bfloat16) * 3.2)(D, F) * (D ** -0.5)),
            "b1": _w((lambda *s: torch.randn(*s, dtype=torch.bfloat16) * 3.2)(F)),
            "w2": _w((lambda *s: torch.randn(*s, dtype=torch.bfloat16) * 3.2)(F, D) * (F ** -0.5)),
            "b2": _w((lambda *s: torch.randn(*s, dtype=torch.bfloat16) * 3.2)(D)),
        }
    _B_in = _B_setup()

    return {
        "A_x": _A_in["x"],
        "A_k_cache": _A_in["k_cache"],
        "A_v_cache": _A_in["v_cache"],
        "A_wq": _A_in["wq"],
        "A_wo": _A_in["wo"],
        "B_x": _B_in["x"],
        "B_w1": _B_in["w1"],
        "B_b1": _B_in["b1"],
        "B_w2": _B_in["w2"],
        "B_b2": _B_in["b2"],
    }

def reference(A_x, A_k_cache, A_v_cache, A_wq, A_wo, B_x, B_w1, B_b1, B_w2, B_b2):
    def _A_ref(x, k_cache, v_cache, wq, wo):
        B, Sq, D = x.shape
        Hq, Dh = 32, 128
        Hkv, Sk = k_cache.shape[1], k_cache.shape[2]
        W = min(4096, max(256, Sk // 4))
        rep = Hq // Hkv
        q = (lambda x, *d: x.permute(*d))((x @ wq).reshape(B, Sq, Hq, Dh), 0, 2, 1, 3)
        k = (lambda x, n, axis: torch.repeat_interleave(x, n, dim=axis))(k_cache[:, :, Sk - W:, :], rep, axis=1)
        v = (lambda x, n, axis: torch.repeat_interleave(x, n, dim=axis))(v_cache[:, :, Sk - W:, :], rep, axis=1)
        scores = torch.einsum("bhqd,bhkd->bhqk", q, k) * (Dh ** -0.5)
        p = _softmax(scores, axis=-1)
        o = torch.einsum("bhqk,bhkd->bhqd", p, v)
        return (lambda x, *d: x.permute(*d))(o, 0, 2, 1, 3).reshape(B, Sq, Hq * Dh) @ wo

    def _B_ref(x, w1, b1, w2, b2):
        y = _layernorm(x, axis=-1)
        h = _gelu(torch.einsum("bsd,df->bsf", y, w1) + b1)
        return torch.einsum("bsf,fd->bsd", h, w2) + b2

    x = A_x
    xn = _layernorm(x, axis=-1)
    s = _A_ref(xn, A_k_cache, A_v_cache, A_wq, A_wo)
    g = _silu(_B_ref(xn, B_w1, B_b1, B_w2, B_b2))
    return x + s * g
```

```asm
; @launch grid=(256,1,1) block=(768,1,1) lds=41216
.amdgcn_target "amdgcn-amd-amdhsa--gfx950"
.text
.globl recurrent_scan__sliding_block_cached__mixer_channel_mlp__decode_kernel
.p2align 8
.type recurrent_scan__sliding_block_cached__mixer_channel_mlp__decode_kernel,@function
recurrent_scan__sliding_block_cached__mixer_channel_mlp__decode_kernel:
    s_cmp_ge_u32 s2, 256
    s_cbranch_scc1 L_end
    s_load_dwordx16 s[4:19], s[0:1], 0
    s_load_dwordx8 s[20:27], s[0:1], 64
    s_load_dwordx2 s[28:29], s[0:1], 96
    v_lshrrev_b32 v1, 6, v0
    v_and_b32 v0, 63, v0
    v_readfirstlane_b32 s3, v1
    s_lshr_b32 s30, s2, 3
    s_and_b32 s31, s2, 7
    s_cmp_lg_u32 s3, 3
    s_cbranch_scc1 L_nopf
    s_getpc_b64 s[86:87]
L_pc:
    s_lshr_b32 s44, s2, 3
    s_and_b32 s44, s44, 15
    s_min_u32 s44, s44, 10
    s_lshl_b32 s44, s44, 10
    v_lshl_add_u32 v100, v0, 4, s44
    v_mov_b32 v101, s87
    v_add_co_u32 v100, vcc, s86, v100
    s_nop 1
    v_addc_co_u32 v101, vcc, 0, v101, vcc
    global_load_dwordx4 v[104:107], v[100:101], off
L_nopf:
    v_mov_b32 v1, 0
    v_mov_b32 v39, 1
    s_cmp_ge_u32 s3, 4
    s_cbranch_scc1 L_main
    s_setprio 3
    v_lshlrev_b32 v2, 4, v0
    v_lshrrev_b32 v3, 3, v0
    v_and_b32 v4, 7, v0
    s_cmp_ge_u32 s3, 2
    s_cbranch_scc1 L_h2_par
    s_lshr_b32 s48, s31, 1
    s_lshl_b32 s44, s48, 20
    s_lshl_b32 s45, s30, 8
    s_add_u32 s44, s44, s45
    s_andn2_b32 s45, 1, s31
    s_lshl_b32 s45, s45, 7
    s_add_u32 s44, s44, s45
    s_lshl_b32 s45, s3, 16
    s_add_u32 s44, s44, s45
    s_movk_i32 s50, 0x2000
    s_mov_b32 s51, 0x20000
    s_mov_b32 s38, 0x400000
    s_waitcnt lgkmcnt(0)
    s_mov_b64 s[36:37], s[10:11]
    s_branch L_h_issue
L_h2_par:
    s_cmp_eq_u32 s3, 3
    s_cbranch_scc1 L_h3_par
    s_lshr_b32 s44, s31, 1
    s_lshl2_add_u32 s63, s30, s44
    s_and_b32 s44, s31, 1
    s_lshl_b32 s44, s44, 7
    s_add_u32 s63, s63, s44
    s_mul_i32 s48, s63, 1525
    s_lshr_b32 s48, s48, 16
    s_mul_i32 s44, s48, 43
    s_sub_u32 s49, s63, s44
    s_mul_i32 s44, s48, 352256
    s_lshl_b32 s45, s49, 7
    s_add_u32 s44, s44, s45
    s_movk_i32 s50, 5504
    s_mov_b32 s51, 44032
    s_mov_b32 s38, 1409024
    s_waitcnt lgkmcnt(0)
    s_mov_b64 s[36:37], s[16:17]
L_h_issue:
    s_load_dword s46, s[28:29], 0
    s_mov_b32 s39, 0x20000
    s_mov_b32 s32, s4
    s_mov_b32 s33, s5
    s_mov_b32 s34, 1024
    s_mov_b32 s35, 0x20000
    v_mul_u32_u24 v5, s51, v3
    v_lshl_add_u32 v5, v4, 4, v5
    buffer_load_dwordx4 v[8:11], v2, s[32:35], 0 offen
    buffer_load_dwordx4 v[40:43], v5, s[36:39], s44 offen nt
    s_add_u32 s44, s44, s50
    buffer_load_dwordx4 v[44:47], v5, s[36:39], s44 offen nt
    s_add_u32 s44, s44, s50
    buffer_load_dwordx4 v[48:51], v5, s[36:39], s44 offen nt
    s_add_u32 s44, s44, s50
    buffer_load_dwordx4 v[52:55], v5, s[36:39], s44 offen nt
    s_add_u32 s44, s44, s50
    buffer_load_dwordx4 v[56:59], v5, s[36:39], s44 offen nt
    s_add_u32 s44, s44, s50
    buffer_load_dwordx4 v[60:63], v5, s[36:39], s44 offen nt
    s_add_u32 s44, s44, s50
    buffer_load_dwordx4 v[64:67], v5, s[36:39], s44 offen nt
    s_add_u32 s44, s44, s50
    buffer_load_dwordx4 v[68:71], v5, s[36:39], s44 offen nt
L_h_issued:
    s_barrier
    s_branch L_helper
L_h3_par:
    v_lshlrev_b32 v36, 2, v0
    ds_write_b32 v36, v1 offset:3328
    s_mul_i32 s48, s30, 48
    s_lshl_b32 s44, s48, 10
    s_lshl_b32 s45, s31, 7
    s_add_u32 s62, s44, s45
    v_lshlrev_b32 v5, 10, v3
    v_lshl_add_u32 v5, v4, 4, v5
    v_and_b32 v7, 15, v0
    v_lshrrev_b32 v36, 4, v0
    v_lshl_add_u32 v7, v7, 2, v36
    v_lshlrev_b32 v7, 1, v7
    s_lshl_b32 s45, s48, 1
    s_waitcnt lgkmcnt(0)
    s_load_dword s46, s[28:29], 0
    s_mov_b32 s36, s20
    s_mov_b32 s37, s21
    s_mov_b32 s38, 1409024
    s_mov_b32 s39, 0x20000
    s_mov_b32 s40, s18
    s_mov_b32 s41, s19
    s_mov_b32 s42, 2752
    s_mov_b32 s43, 0x20000
    s_add_u32 s88, s62, 8192
    s_add_u32 s89, s62, 16384
    s_add_u32 s90, s62, 24576
    s_add_u32 s91, s62, 32768
    s_add_u32 s92, s62, 40960
    buffer_load_dwordx4 v[72:75], v5, s[36:39], s62 offen nt
    buffer_load_dwordx4 v[76:79], v5, s[36:39], s88 offen nt
    buffer_load_dwordx4 v[80:83], v5, s[36:39], s89 offen nt
    buffer_load_dwordx4 v[84:87], v5, s[36:39], s90 offen nt
    buffer_load_dwordx4 v[88:91], v5, s[36:39], s91 offen nt
    buffer_load_dwordx4 v[92:95], v5, s[36:39], s92 offen nt
    buffer_load_ushort v28, v7, s[40:43], s45 offen
    s_branch L_h_issued
L_main:
    s_sub_u32 s62, s3, 4
    s_setprio 2
    s_lshl_b32 s44, s30, 23
    s_add_u32 s44, s44, 0x700000
    s_and_b32 s45, s30, 3
    s_lshr_b32 s46, s30, 2
    s_lshl3_add_u32 s45, s45, s46
    s_mul_i32 s45, s45, 5
    s_mul_i32 s46, s31, 48
    s_add_u32 s45, s45, s46
    s_lshr_b32 s46, s62, 2
    s_bfe_u32 s47, s45, 0x10006
    s_xor_b32 s46, s46, s47
    s_brev_b32 s47, s31
    s_lshr_b32 s47, s47, 30
    s_lshl1_add_u32 s46, s47, s46
    s_lshr_b32 s47, s31, 2
    s_lshl1_add_u32 s46, s46, s47
    s_lshl_b32 s46, s46, 16
    s_add_u32 s44, s44, s46
    s_and_b32 s61, s62, 3
    s_add_u32 s46, s61, s45
    s_add_u32 s47, s46, 0
    s_and_b32 s47, s47, 15
    s_lshl_b32 s47, s47, 10
    v_lshl_add_u32 v2, v0, 4, s47
    s_add_u32 s47, s46, 4
    s_and_b32 s47, s47, 15
    s_lshl_b32 s47, s47, 10
    v_lshl_add_u32 v3, v0, 4, s47
    s_add_u32 s47, s46, 8
    s_and_b32 s47, s47, 15
    s_lshl_b32 s47, s47, 10
    v_lshl_add_u32 v4, v0, 4, s47
    s_add_u32 s47, s46, 12
    s_and_b32 s47, s47, 15
    s_lshl_b32 s47, s47, 10
    v_lshl_add_u32 v5, v0, 4, s47
    s_lshr_b32 s46, s45, 4
    s_add_u32 s47, s46, 0
    s_and_b32 s47, s47, 3
    s_lshl_b32 s40, s47, 14
    s_add_u32 s47, s46, 1
    s_and_b32 s47, s47, 3
    s_lshl_b32 s41, s47, 14
    s_add_u32 s47, s46, 2
    s_and_b32 s47, s47, 3
    s_lshl_b32 s42, s47, 14
    s_add_u32 s47, s46, 3
    s_and_b32 s47, s47, 3
    s_lshl_b32 s43, s47, 14
    s_cmp_ge_u32 s62, 4
    s_cbranch_scc1 L_y0
    s_waitcnt lgkmcnt(0)
    s_add_u32 s32, s6, s44
    s_addc_u32 s33, s7, 0
    s_mov_b32 s34, 65536
    s_mov_b32 s35, 0x20000
    buffer_load_dwordx4 v[40:43], v2, s[32:35], s40 offen nt
    s_barrier
    s_branch L_y1
L_y0:
    s_barrier
    s_waitcnt lgkmcnt(0)
    s_add_u32 s32, s6, s44
    s_addc_u32 s33, s7, 0
    s_mov_b32 s34, 65536
    s_mov_b32 s35, 0x20000
    buffer_load_dwordx4 v[40:43], v2, s[32:35], s40 offen nt
L_y1:
    s_add_u32 s36, s8, s44
    s_addc_u32 s37, s9, 0
    s_mov_b32 s38, 65536
    s_mov_b32 s39, 0x20000
    buffer_load_dwordx4 v[44:47], v3, s[32:35], s40 offen nt
    buffer_load_dwordx4 v[48:51], v4, s[32:35], s40 offen nt
    buffer_load_dwordx4 v[52:55], v5, s[32:35], s40 offen nt
    buffer_load_dwordx4 v[56:59], v2, s[32:35], s41 offen nt
    buffer_load_dwordx4 v[60:63], v3, s[32:35], s41 offen nt
    buffer_load_dwordx4 v[64:67], v4, s[32:35], s41 offen nt
    buffer_load_dwordx4 v[68:71], v5, s[32:35], s41 offen nt
    buffer_load_dwordx4 v[72:75], v2, s[32:35], s42 offen nt
    buffer_load_dwordx4 v[76:79], v3, s[32:35], s42 offen nt
    buffer_load_dwordx4 v[80:83], v4, s[32:35], s42 offen nt
    buffer_load_dwordx4 v[84:87], v5, s[32:35], s42 offen nt
    s_load_dword s46, s[28:29], 0
    s_mov_b32 s52, s28
    s_mov_b32 s53, s29
    s_mov_b32 s54, 2097152
    s_mov_b32 s55, 0x20000
    v_and_b32 v36, 1, v0
    v_lshlrev_b32 v36, 4, v36
    v_mov_b32 v37, 0xffff
    v_lshlrev_b32 v36, v36, v37
    v_and_b32 v37, 15, v0
    v_lshrrev_b32 v37, 1, v37
    v_cmp_eq_u32 vcc, 0, v37
    s_nop 1
    v_cndmask_b32 v28, 0, v36, vcc
    v_cmp_eq_u32 vcc, 1, v37
    s_nop 1
    v_cndmask_b32 v29, 0, v36, vcc
    v_cmp_eq_u32 vcc, 2, v37
    s_nop 1
    v_cndmask_b32 v30, 0, v36, vcc
    v_cmp_eq_u32 vcc, 3, v37
    s_nop 1
    v_cndmask_b32 v31, 0, v36, vcc
    v_and_b32 v7, 15, v0
    v_lshlrev_b32 v7, 4, v7
    s_mov_b32 s48, 0xcccccccc
    s_mov_b32 s49, 0xcccccccc
    s_mov_b32 s50, 0xaaaaaaaa
    s_mov_b32 s51, 0xaaaaaaaa
    buffer_load_dwordx4 v[88:91], v2, s[32:35], s43 offen nt
    buffer_load_dwordx4 v[92:95], v3, s[32:35], s43 offen nt
    buffer_load_dwordx4 v[96:99], v4, s[32:35], s43 offen nt
    buffer_load_dwordx4 v[100:103], v5, s[32:35], s43 offen nt
    s_setprio 1
    buffer_load_dwordx4 v[104:107], v2, s[36:39], s40 offen nt
    buffer_load_dwordx4 v[108:111], v3, s[36:39], s40 offen nt
    buffer_load_dwordx4 v[112:115], v4, s[36:39], s40 offen nt
    buffer_load_dwordx4 v[116:119], v5, s[36:39], s40 offen nt
    buffer_load_dwordx4 v[120:123], v2, s[36:39], s41 offen nt
    buffer_load_dwordx4 v[124:127], v3, s[36:39], s41 offen nt
    buffer_load_dwordx4 v[128:131], v4, s[36:39], s41 offen nt
    s_waitcnt vmcnt(7)
    s_mov_b32 s45, 0
L_mq:
    ds_read_b32 v36, v1 offset:3340
    ds_read_b128 v[8:11], v7 offset:3072
    s_add_u32 s45, s45, 1
    s_waitcnt lgkmcnt(0)
    v_readfirstlane_b32 s44, v36
    s_nop 0
    s_cmp_ge_u32 s44, 1
    s_cbranch_scc1 L_mq_ok
    s_sleep 2
    s_cmp_lt_u32 s45, 3200000
    s_cbranch_scc1 L_mq
L_mq_ok:
    s_mul_i32 s47, s46, 0x9e3779b1
    s_add_u32 s47, s47, 0x7f4a7c15
    v_dot2_f32_bf16 v12, v40, v8, 0
    v_dot2_f32_bf16 v13, v44, v8, 0
    v_dot2_f32_bf16 v14, v48, v8, 0
    v_dot2_f32_bf16 v15, v52, v8, 0
    v_dot2_f32_bf16 v16, v56, v8, 0
    v_dot2_f32_bf16 v17, v60, v8, 0
    v_dot2_f32_bf16 v18, v64, v8, 0
    v_dot2_f32_bf16 v19, v68, v8, 0
    v_dot2_f32_bf16 v20, v72, v8, 0
    v_dot2_f32_bf16 v21, v76, v8, 0
    v_dot2_f32_bf16 v22, v80, v8, 0
    v_dot2_f32_bf16 v23, v84, v8, 0
    v_dot2_f32_bf16 v24, v88, v8, 0
    v_dot2_f32_bf16 v25, v92, v8, 0
    v_dot2_f32_bf16 v26, v96, v8, 0
    v_dot2_f32_bf16 v27, v100, v8, 0
    buffer_load_dwordx4 v[132:135], v5, s[36:39], s41 offen nt
    v_dot2_f32_bf16 v12, v41, v9, v12
    v_dot2_f32_bf16 v13, v45, v9, v13
    v_dot2_f32_bf16 v14, v49, v9, v14
    v_dot2_f32_bf16 v15, v53, v9, v15
    v_dot2_f32_bf16 v16, v57, v9, v16
    v_dot2_f32_bf16 v17, v61, v9, v17
    v_dot2_f32_bf16 v18, v65, v9, v18
    v_dot2_f32_bf16 v19, v69, v9, v19
    v_dot2_f32_bf16 v20, v73, v9, v20
    v_dot2_f32_bf16 v21, v77, v9, v21
    v_dot2_f32_bf16 v22, v81, v9, v22
    v_dot2_f32_bf16 v23, v85, v9, v23
    v_dot2_f32_bf16 v24, v89, v9, v24
    v_dot2_f32_bf16 v25, v93, v9, v25
    v_dot2_f32_bf16 v26, v97, v9, v26
    v_dot2_f32_bf16 v27, v101, v9, v27
    buffer_load_dwordx4 v[136:139], v2, s[36:39], s42 offen nt
    v_dot2_f32_bf16 v12, v42, v10, v12
    v_dot2_f32_bf16 v13, v46, v10, v13
    v_dot2_f32_bf16 v14, v50, v10, v14
    v_dot2_f32_bf16 v15, v54, v10, v15
    v_dot2_f32_bf16 v16, v58, v10, v16
    v_dot2_f32_bf16 v17, v62, v10, v17
    v_dot2_f32_bf16 v18, v66, v10, v18
    v_dot2_f32_bf16 v19, v70, v10, v19
    v_dot2_f32_bf16 v20, v74, v10, v20
    v_dot2_f32_bf16 v21, v78, v10, v21
    v_dot2_f32_bf16 v22, v82, v10, v22
    v_dot2_f32_bf16 v23, v86, v10, v23
    v_dot2_f32_bf16 v24, v90, v10, v24
    v_dot2_f32_bf16 v25, v94, v10, v25
    v_dot2_f32_bf16 v26, v98, v10, v26
    v_dot2_f32_bf16 v27, v102, v10, v27
    buffer_load_dwordx4 v[140:143], v3, s[36:39], s42 offen nt
    v_dot2_f32_bf16 v12, v43, v11, v12
    v_dot2_f32_bf16 v13, v47, v11, v13
    v_dot2_f32_bf16 v14, v51, v11, v14
    v_dot2_f32_bf16 v15, v55, v11, v15
    v_dot2_f32_bf16 v16, v59, v11, v16
    v_dot2_f32_bf16 v17, v63, v11, v17
    v_dot2_f32_bf16 v18, v67, v11, v18
    v_dot2_f32_bf16 v19, v71, v11, v19
    v_dot2_f32_bf16 v20, v75, v11, v20
    v_dot2_f32_bf16 v21, v79, v11, v21
    v_dot2_f32_bf16 v22, v83, v11, v22
    v_dot2_f32_bf16 v23, v87, v11, v23
    v_dot2_f32_bf16 v24, v91, v11, v24
    v_dot2_f32_bf16 v25, v95, v11, v25
    v_dot2_f32_bf16 v26, v99, v11, v26
    v_dot2_f32_bf16 v27, v103, v11, v27
    buffer_load_dwordx4 v[144:147], v4, s[36:39], s42 offen nt
    v_add_f32_dpp v12, v12, v12 row_ror:8 row_mask:0xf bank_mask:0x3
    v_add_f32_dpp v13, v13, v13 row_ror:8 row_mask:0xf bank_mask:0x3
    v_add_f32_dpp v14, v14, v14 row_ror:8 row_mask:0xf bank_mask:0x3
    v_add_f32_dpp v15, v15, v15 row_ror:8 row_mask:0xf bank_mask:0x3
    v_add_f32_dpp v16, v16, v16 row_ror:8 row_mask:0xf bank_mask:0x3
    v_add_f32_dpp v17, v17, v17 row_ror:8 row_mask:0xf bank_mask:0x3
    v_add_f32_dpp v18, v18, v18 row_ror:8 row_mask:0xf bank_mask:0x3
    v_add_f32_dpp v19, v19, v19 row_ror:8 row_mask:0xf bank_mask:0x3
    v_add_f32_dpp v12, v20, v20 row_ror:8 row_mask:0xf bank_mask:0xc
    v_add_f32_dpp v13, v21, v21 row_ror:8 row_mask:0xf bank_mask:0xc
    v_add_f32_dpp v14, v22, v22 row_ror:8 row_mask:0xf bank_mask:0xc
    v_add_f32_dpp v15, v23, v23 row_ror:8 row_mask:0xf bank_mask:0xc
    v_add_f32_dpp v16, v24, v24 row_ror:8 row_mask:0xf bank_mask:0xc
    v_add_f32_dpp v17, v25, v25 row_ror:8 row_mask:0xf bank_mask:0xc
    v_add_f32_dpp v18, v26, v26 row_ror:8 row_mask:0xf bank_mask:0xc
    v_add_f32_dpp v19, v27, v27 row_ror:8 row_mask:0xf bank_mask:0xc
    buffer_load_dwordx4 v[148:151], v5, s[36:39], s42 offen nt
    v_add_f32_dpp v12, v12, v12 row_half_mirror row_mask:0xf bank_mask:0x5
    v_add_f32_dpp v13, v13, v13 row_half_mirror row_mask:0xf bank_mask:0x5
    v_add_f32_dpp v14, v14, v14 row_half_mirror row_mask:0xf bank_mask:0x5
    v_add_f32_dpp v15, v15, v15 row_half_mirror row_mask:0xf bank_mask:0x5
    v_add_f32_dpp v12, v16, v16 row_half_mirror row_mask:0xf bank_mask:0xa
    v_add_f32_dpp v13, v17, v17 row_half_mirror row_mask:0xf bank_mask:0xa
    v_add_f32_dpp v14, v18, v18 row_half_mirror row_mask:0xf bank_mask:0xa
    v_add_f32_dpp v15, v19, v19 row_half_mirror row_mask:0xf bank_mask:0xa
    v_add_f32_dpp v12, v12, v12 quad_perm:[2,3,0,1] row_mask:0xf bank_mask:0xf
    v_add_f32_dpp v13, v13, v13 quad_perm:[2,3,0,1] row_mask:0xf bank_mask:0xf
    v_add_f32_dpp v14, v14, v14 quad_perm:[2,3,0,1] row_mask:0xf bank_mask:0xf
    v_add_f32_dpp v15, v15, v15 quad_perm:[2,3,0,1] row_mask:0xf bank_mask:0xf
    v_cndmask_b32 v12, v12, v14, s[48:49]
    v_cndmask_b32 v13, v13, v15, s[48:49]
    s_nop 0
    v_add_f32_dpp v12, v12, v12 quad_perm:[1,0,3,2] row_mask:0xf bank_mask:0xf
    v_add_f32_dpp v13, v13, v13 quad_perm:[1,0,3,2] row_mask:0xf bank_mask:0xf
    v_cndmask_b32 v12, v12, v13, s[50:51]
    v_cvt_pk_bf16_f32 v12, v12, v12
    v_and_b32 v12, 0xffff0000, v12
    v_mul_f32 v12, 0x3db504f3, v12
    v_cvt_pk_bf16_f32 v12, v12, v12
    v_and_b32 v12, 0xffff0000, v12
    v_mov_b32 v14, v12
    s_nop 1
    v_max_f32_dpp v14, v14, v14 row_ror:8 row_mask:0xf bank_mask:0xf
    s_nop 1
    v_max_f32_dpp v14, v14, v14 row_ror:4 row_mask:0xf bank_mask:0xf
    s_nop 1
    v_max_f32_dpp v14, v14, v14 row_ror:2 row_mask:0xf bank_mask:0xf
    s_nop 1
    v_max_f32_dpp v14, v14, v14 row_ror:1 row_mask:0xf bank_mask:0xf
    v_mov_b32 v13, v14
    s_nop 1
    v_permlane16_swap_b32 v14, v13
    v_max_f32 v14, v14, v13
    v_mov_b32 v13, v14
    s_nop 1
    v_permlane32_swap_b32 v14, v13
    v_max_f32 v14, v14, v13
    v_sub_f32 v12, v12, v14
    v_mul_f32 v12, 0x3fb8aa3b, v12
    v_exp_f32 v12, v12
    s_nop 0
    v_mov_b32 v15, v12
    v_cvt_pk_bf16_f32 v16, v12, v12
    s_nop 0
    v_add_f32_dpp v15, v15, v15 row_ror:8 row_mask:0xf bank_mask:0xf
    s_nop 1
    v_add_f32_dpp v15, v15, v15 row_ror:4 row_mask:0xf bank_mask:0xf
    s_nop 1
    v_add_f32_dpp v15, v15, v15 row_ror:2 row_mask:0xf bank_mask:0xf
    s_nop 1
    v_add_f32_dpp v15, v15, v15 row_ror:1 row_mask:0xf bank_mask:0xf
    v_mov_b32 v13, v15
    s_nop 1
    v_permlane16_swap_b32 v15, v13
    v_add_f32 v15, v15, v13
    v_mov_b32 v13, v15
    s_nop 1
    v_permlane32_swap_b32 v15, v13
    v_add_f32 v15, v15, v13
    s_lshl_b32 s44, s62, 3
    v_mov_b32 v13, s44
    s_mov_b64 exec, 1
    ds_write_b64 v13, v[14:15] offset:3584
    ds_add_u32 v1, v39 offset:3328
    s_mov_b64 exec, -1
    buffer_load_dwordx4 v[152:155], v2, s[36:39], s43 offen nt
    v_and_b32_dpp v40, v16, v28 row_newbcast:0 row_mask:0xf bank_mask:0xf
    v_and_b32_dpp v41, v16, v29 row_newbcast:0 row_mask:0xf bank_mask:0xf
    v_and_b32_dpp v42, v16, v30 row_newbcast:0 row_mask:0xf bank_mask:0xf
    v_and_b32_dpp v43, v16, v31 row_newbcast:0 row_mask:0xf bank_mask:0xf
    v_and_b32_dpp v44, v16, v28 row_newbcast:1 row_mask:0xf bank_mask:0xf
    v_and_b32_dpp v45, v16, v29 row_newbcast:1 row_mask:0xf bank_mask:0xf
    v_and_b32_dpp v46, v16, v30 row_newbcast:1 row_mask:0xf bank_mask:0xf
    v_and_b32_dpp v47, v16, v31 row_newbcast:1 row_mask:0xf bank_mask:0xf
    v_and_b32_dpp v48, v16, v28 row_newbcast:2 row_mask:0xf bank_mask:0xf
    v_and_b32_dpp v49, v16, v29 row_newbcast:2 row_mask:0xf bank_mask:0xf
    v_and_b32_dpp v50, v16, v30 row_newbcast:2 row_mask:0xf bank_mask:0xf
    v_and_b32_dpp v51, v16, v31 row_newbcast:2 row_mask:0xf bank_mask:0xf
    v_and_b32_dpp v52, v16, v28 row_newbcast:3 row_mask:0xf bank_mask:0xf
    v_and_b32_dpp v53, v16, v29 row_newbcast:3 row_mask:0xf bank_mask:0xf
    v_and_b32_dpp v54, v16, v30 row_newbcast:3 row_mask:0xf bank_mask:0xf
    v_and_b32_dpp v55, v16, v31 row_newbcast:3 row_mask:0xf bank_mask:0xf
    buffer_load_dwordx4 v[156:159], v3, s[36:39], s43 offen nt
    v_and_b32_dpp v56, v16, v28 row_newbcast:4 row_mask:0xf bank_mask:0xf
    v_and_b32_dpp v57, v16, v29 row_newbcast:4 row_mask:0xf bank_mask:0xf
    v_and_b32_dpp v58, v16, v30 row_newbcast:4 row_mask:0xf bank_mask:0xf
    v_and_b32_dpp v59, v16, v31 row_newbcast:4 row_mask:0xf bank_mask:0xf
    v_and_b32_dpp v60, v16, v28 row_newbcast:5 row_mask:0xf bank_mask:0xf
    v_and_b32_dpp v61, v16, v29 row_newbcast:5 row_mask:0xf bank_mask:0xf
    v_and_b32_dpp v62, v16, v30 row_newbcast:5 row_mask:0xf bank_mask:0xf
    v_and_b32_dpp v63, v16, v31 row_newbcast:5 row_mask:0xf bank_mask:0xf
    v_and_b32_dpp v64, v16, v28 row_newbcast:6 row_mask:0xf bank_mask:0xf
    v_and_b32_dpp v65, v16, v29 row_newbcast:6 row_mask:0xf bank_mask:0xf
    v_and_b32_dpp v66, v16, v30 row_newbcast:6 row_mask:0xf bank_mask:0xf
    v_and_b32_dpp v67, v16, v31 row_newbcast:6 row_mask:0xf bank_mask:0xf
    v_and_b32_dpp v68, v16, v28 row_newbcast:7 row_mask:0xf bank_mask:0xf
    v_and_b32_dpp v69, v16, v29 row_newbcast:7 row_mask:0xf bank_mask:0xf
    v_and_b32_dpp v70, v16, v30 row_newbcast:7 row_mask:0xf bank_mask:0xf
    v_and_b32_dpp v71, v16, v31 row_newbcast:7 row_mask:0xf bank_mask:0xf
    buffer_load_dwordx4 v[160:163], v4, s[36:39], s43 offen nt
    v_and_b32_dpp v72, v16, v28 row_newbcast:8 row_mask:0xf bank_mask:0xf
    v_and_b32_dpp v73, v16, v29 row_newbcast:8 row_mask:0xf bank_mask:0xf
    v_and_b32_dpp v74, v16, v30 row_newbcast:8 row_mask:0xf bank_mask:0xf
    v_and_b32_dpp v75, v16, v31 row_newbcast:8 row_mask:0xf bank_mask:0xf
    v_and_b32_dpp v76, v16, v28 row_newbcast:9 row_mask:0xf bank_mask:0xf
    v_and_b32_dpp v77, v16, v29 row_newbcast:9 row_mask:0xf bank_mask:0xf
    v_and_b32_dpp v78, v16, v30 row_newbcast:9 row_mask:0xf bank_mask:0xf
    v_and_b32_dpp v79, v16, v31 row_newbcast:9 row_mask:0xf bank_mask:0xf
    v_and_b32_dpp v80, v16, v28 row_newbcast:10 row_mask:0xf bank_mask:0xf
    v_and_b32_dpp v81, v16, v29 row_newbcast:10 row_mask:0xf bank_mask:0xf
    v_and_b32_dpp v82, v16, v30 row_newbcast:10 row_mask:0xf bank_mask:0xf
    v_and_b32_dpp v83, v16, v31 row_newbcast:10 row_mask:0xf bank_mask:0xf
    v_and_b32_dpp v84, v16, v28 row_newbcast:11 row_mask:0xf bank_mask:0xf
    v_and_b32_dpp v85, v16, v29 row_newbcast:11 row_mask:0xf bank_mask:0xf
    v_and_b32_dpp v86, v16, v30 row_newbcast:11 row_mask:0xf bank_mask:0xf
    v_and_b32_dpp v87, v16, v31 row_newbcast:11 row_mask:0xf bank_mask:0xf
    buffer_load_dwordx4 v[164:167], v5, s[36:39], s43 offen nt
    v_and_b32_dpp v88, v16, v28 row_newbcast:12 row_mask:0xf bank_mask:0xf
    v_and_b32_dpp v89, v16, v29 row_newbcast:12 row_mask:0xf bank_mask:0xf
    v_and_b32_dpp v90, v16, v30 row_newbcast:12 row_mask:0xf bank_mask:0xf
    v_and_b32_dpp v91, v16, v31 row_newbcast:12 row_mask:0xf bank_mask:0xf
    v_and_b32_dpp v92, v16, v28 row_newbcast:13 row_mask:0xf bank_mask:0xf
    v_and_b32_dpp v93, v16, v29 row_newbcast:13 row_mask:0xf bank_mask:0xf
    v_and_b32_dpp v94, v16, v30 row_newbcast:13 row_mask:0xf bank_mask:0xf
    v_and_b32_dpp v95, v16, v31 row_newbcast:13 row_mask:0xf bank_mask:0xf
    v_and_b32_dpp v96, v16, v28 row_newbcast:14 row_mask:0xf bank_mask:0xf
    v_and_b32_dpp v97, v16, v29 row_newbcast:14 row_mask:0xf bank_mask:0xf
    v_and_b32_dpp v98, v16, v30 row_newbcast:14 row_mask:0xf bank_mask:0xf
    v_and_b32_dpp v99, v16, v31 row_newbcast:14 row_mask:0xf bank_mask:0xf
    v_and_b32_dpp v100, v16, v28 row_newbcast:15 row_mask:0xf bank_mask:0xf
    v_and_b32_dpp v101, v16, v29 row_newbcast:15 row_mask:0xf bank_mask:0xf
    v_and_b32_dpp v102, v16, v30 row_newbcast:15 row_mask:0xf bank_mask:0xf
    v_and_b32_dpp v103, v16, v31 row_newbcast:15 row_mask:0xf bank_mask:0xf
    v_and_b32 v13, 7, v0
    v_lshrrev_b32 v25, 4, v0
    v_lshl_add_u32 v24, v25, 3, v13
    v_lshlrev_b32 v24, 4, v24
    v_lshlrev_b32 v13, 3, v13
    v_and_b32 v22, 8, v0
    v_add_u32 v22, v22, v24
    s_lshl_b32 s44, s62, 9
    v_lshl_add_u32 v20, v0, 4, s44
    s_lshl_b32 s63, s2, 9
    s_add_u32 s63, s63, 524288
    s_mov_b32 s45, 0
L_mst:
    ds_read_b32 v18, v1 offset:3328
    ds_read_b64 v[26:27], v13 offset:3584
    s_add_u32 s45, s45, 1
    s_waitcnt lgkmcnt(0)
    v_readfirstlane_b32 s44, v18
    s_nop 0
    s_cmp_ge_u32 s44, 8
    s_cbranch_scc1 L_mst_ok
    s_sleep 2
    s_cmp_lt_u32 s45, 3200000
    s_cbranch_scc1 L_mst
L_mst_ok:
    v_mov_b32 v9, v26
    s_nop 1
    v_max_f32_dpp v9, v9, v9 quad_perm:[1,0,3,2] row_mask:0xf bank_mask:0xf
    s_nop 1
    v_max_f32_dpp v9, v9, v9 quad_perm:[2,3,0,1] row_mask:0xf bank_mask:0xf
    s_nop 1
    v_max_f32_dpp v9, v9, v9 row_half_mirror row_mask:0xf bank_mask:0xf
    v_sub_f32 v19, v14, v9
    v_mul_f32 v19, 0x3fb8aa3b, v19
    v_exp_f32 v19, v19
    v_sub_f32 v26, v26, v9
    v_mul_f32 v26, 0x3fb8aa3b, v26
    v_exp_f32 v26, v26
    s_nop 0
    v_mul_f32 v10, v26, v27
    s_nop 1
    v_add_f32_dpp v10, v10, v10 quad_perm:[1,0,3,2] row_mask:0xf bank_mask:0xf
    s_nop 1
    v_add_f32_dpp v10, v10, v10 quad_perm:[2,3,0,1] row_mask:0xf bank_mask:0xf
    s_nop 1
    v_add_f32_dpp v10, v10, v10 row_half_mirror row_mask:0xf bank_mask:0xf
    v_cndmask_b32 v10, v9, v10, s[50:51]
    v_mov_b32 v11, s47
    s_waitcnt vmcnt(15)
    v_mfma_f32_16x16x32_bf16 v[32:35], v[40:43], v[104:107], 0
    s_waitcnt vmcnt(14)
    v_mfma_f32_16x16x32_bf16 v[32:35], v[44:47], v[108:111], v[32:35]
    s_waitcnt vmcnt(13)
    v_mfma_f32_16x16x32_bf16 v[32:35], v[48:51], v[112:115], v[32:35]
    s_waitcnt vmcnt(12)
    v_mfma_f32_16x16x32_bf16 v[32:35], v[52:55], v[116:119], v[32:35]
    s_waitcnt vmcnt(11)
    v_mfma_f32_16x16x32_bf16 v[32:35], v[56:59], v[120:123], v[32:35]
    s_waitcnt vmcnt(10)
    v_mfma_f32_16x16x32_bf16 v[32:35], v[60:63], v[124:127], v[32:35]
    s_waitcnt vmcnt(9)
    v_mfma_f32_16x16x32_bf16 v[32:35], v[64:67], v[128:131], v[32:35]
    s_waitcnt vmcnt(8)
    v_mfma_f32_16x16x32_bf16 v[32:35], v[68:71], v[132:135], v[32:35]
    s_waitcnt vmcnt(7)
    v_mfma_f32_16x16x32_bf16 v[32:35], v[72:75], v[136:139], v[32:35]
    s_waitcnt vmcnt(6)
    v_mfma_f32_16x16x32_bf16 v[32:35], v[76:79], v[140:143], v[32:35]
    s_waitcnt vmcnt(5)
    v_mfma_f32_16x16x32_bf16 v[32:35], v[80:83], v[144:147], v[32:35]
    s_mov_b64 exec, 1
    ds_add_u32 v1, v39 offset:3352
    s_mov_b64 exec, -1
    s_waitcnt vmcnt(4)
    v_mfma_f32_16x16x32_bf16 v[32:35], v[84:87], v[148:151], v[32:35]
    s_waitcnt vmcnt(3)
    v_mfma_f32_16x16x32_bf16 v[32:35], v[88:91], v[152:155], v[32:35]
    s_waitcnt vmcnt(2)
    v_mfma_f32_16x16x32_bf16 v[32:35], v[92:95], v[156:159], v[32:35]
    s_waitcnt vmcnt(1)
    v_mfma_f32_16x16x32_bf16 v[32:35], v[96:99], v[160:163], v[32:35]
    s_mov_b64 exec, 1
    ds_add_u32 v1, v39 offset:3352
    s_mov_b64 exec, -1
    s_waitcnt vmcnt(0)
    v_mfma_f32_16x16x32_bf16 v[32:35], v[100:103], v[164:167], v[32:35]
    s_mov_b32 exec_hi, 0
    s_nop 6
    v_pk_mul_f32 v[32:33], v[32:33], v[18:19] op_sel:[0,1] op_sel_hi:[1,1]
    v_pk_mul_f32 v[34:35], v[34:35], v[18:19] op_sel:[0,1] op_sel_hi:[1,1]
    ds_write_b128 v20, v[32:35] offset:4096
    s_mov_b64 exec, 1
    ds_add_rtn_u32 v18, v1, v39 offset:3332
    s_mov_b64 exec, -1
    ds_read_b64 v[40:41], v22 offset:4096
    ds_read_b64 v[42:43], v22 offset:4608
    ds_read_b64 v[44:45], v22 offset:5120
    ds_read_b64 v[46:47], v22 offset:5632
    ds_read_b64 v[48:49], v22 offset:6144
    ds_read_b64 v[50:51], v22 offset:6656
    ds_read_b64 v[52:53], v22 offset:7168
    ds_read_b64 v[54:55], v22 offset:7680
    s_waitcnt lgkmcnt(8)
    v_readfirstlane_b32 s44, v18
    s_nop 0
    s_cmp_eq_u32 s44, 7
    s_cbranch_scc0 L_nored
    s_waitcnt lgkmcnt(6)
    v_pk_add_f32 v[40:41], v[40:41], v[42:43]
    s_waitcnt lgkmcnt(4)
    v_pk_add_f32 v[44:45], v[44:45], v[46:47]
    v_pk_add_f32 v[40:41], v[40:41], v[44:45]
    s_waitcnt lgkmcnt(2)
    v_pk_add_f32 v[48:49], v[48:49], v[50:51]
    s_waitcnt lgkmcnt(0)
    v_pk_add_f32 v[52:53], v[52:53], v[54:55]
    v_pk_add_f32 v[48:49], v[48:49], v[52:53]
    v_pk_add_f32 v[40:41], v[40:41], v[48:49]
    v_cvt_pk_bf16_f32 v8, v40, v41
    s_nop 1
    v_mov_b32_dpp v9, v8 row_ror:8 row_mask:0xf bank_mask:0xf
    s_mov_b32 exec_lo, 0x00ff00ff
    s_mov_b32 exec_hi, 0x00ff00ff
    buffer_store_dwordx4 v[8:11], v24, s[52:55], s63 offen sc1
    s_lshr_b32 s44, s31, 1
    s_mul_i32 s44, s44, 1040
    s_and_b32 s45, s31, 1
    s_lshl_b32 s45, s45, 9
    s_add_u32 s44, s44, s45
    v_add_u32 v24, s44, v24
    ds_write_b128 v24, v[8:11] offset:24576
    ds_write_b128 v24, v[8:11] offset:28736
    ds_write_b128 v24, v[8:11] offset:32896
    ds_write_b128 v24, v[8:11] offset:37056
    s_mov_b64 exec, -1
L_nored:
    s_cmp_ge_u32 s62, 4
    s_cbranch_scc1 L_fin
    s_lshl_b32 s60, s30, 17
    s_lshl_b32 s45, s31, 7
    s_add_u32 s60, s60, s45
    s_lshl_b32 s45, s62, 15
    s_add_u32 s60, s60, s45
    s_and_b32 s45, s62, 1
    s_lshl_b32 s45, s45, 2
    v_lshrrev_b32 v3, 3, v0
    v_and_b32 v4, 7, v0
    v_and_b32 v6, 2, v3
    v_xor_b32 v6, s45, v6
    v_xor_b32 v6, v6, v4
    v_lshlrev_b32 v6, 4, v6
    v_lshl_add_u32 v6, v3, 10, v6
    s_lshl_b32 s61, s62, 12
    s_add_u32 s61, s61, 8192
    s_mov_b32 s56, s12
    s_mov_b32 s57, s13
    s_mov_b32 s58, 4194304
    s_mov_b32 s59, 0x20000
    s_bitcmp1_b32 s31, 0
    s_cselect_b32 s84, 12, 16
    s_mov_b32 s45, 0
L_wv:
    ds_read_b32 v18, v1 offset:3352
    s_add_u32 s45, s45, 1
    s_waitcnt lgkmcnt(0)
    v_readfirstlane_b32 s44, v18
    s_nop 0
    s_cmp_ge_u32 s44, s84
    s_cbranch_scc1 L_wv_ok
    s_sleep 1
    s_cmp_lt_u32 s45, 3200000
    s_cbranch_scc1 L_wv
L_wv_ok:
    s_add_u32 m0, s61, 0
    s_nop 0
    buffer_load_dwordx4 v6, s[56:59], s60 offen nt lds
    s_add_u32 s60, s60, 8192
    s_add_u32 m0, s61, 1024
    s_nop 0
    buffer_load_dwordx4 v6, s[56:59], s60 offen nt lds
    s_add_u32 s60, s60, 8192
    s_add_u32 m0, s61, 2048
    s_nop 0
    buffer_load_dwordx4 v6, s[56:59], s60 offen nt lds
    s_add_u32 s60, s60, 8192
    s_add_u32 m0, s61, 3072
    s_nop 0
    buffer_load_dwordx4 v6, s[56:59], s60 offen nt lds
    s_waitcnt vmcnt(0)
    s_mov_b64 exec, 1
    ds_add_u32 v1, v39 offset:3336
    s_branch L_fin
L_helper:
    s_mov_b32 s52, s28
    s_mov_b32 s53, s29
    s_mov_b32 s54, 2097152
    s_mov_b32 s55, 0x20000
    v_and_b32 v36, 1, v0
    v_lshlrev_b32 v36, 4, v36
    v_mov_b32 v37, 0xffff
    v_lshlrev_b32 v36, v36, v37
    v_and_b32 v37, 7, v0
    v_lshrrev_b32 v37, 1, v37
    v_cmp_eq_u32 vcc, 0, v37
    s_nop 1
    v_cndmask_b32 v32, 0, v36, vcc
    v_cmp_eq_u32 vcc, 1, v37
    s_nop 1
    v_cndmask_b32 v33, 0, v36, vcc
    v_cmp_eq_u32 vcc, 2, v37
    s_nop 1
    v_cndmask_b32 v34, 0, v36, vcc
    v_cmp_eq_u32 vcc, 3, v37
    s_nop 1
    v_cndmask_b32 v35, 0, v36, vcc
    v_bfe_u32 v6, v0, 2, 3
    v_and_b32 v36, 2, v0
    v_lshl_add_u32 v6, v36, 3, v6
    v_and_b32 v36, 1, v0
    v_lshl_add_u32 v6, v36, 5, v6
    v_lshlrev_b32 v6, 2, v6
    v_bfe_u32 v98, v0, 1, 3
    v_and_b32 v36, 1, v0
    v_lshl_add_u32 v98, v36, 4, v98
    v_lshlrev_b32 v98, 2, v98
    s_cmp_eq_u32 s3, 3
    s_cbranch_scc1 L_m2
    s_lshl_b32 s44, s48, 8
    s_lshl_b32 s45, s3, 10
    s_add_u32 s44, s44, s45
    v_lshl_add_u32 v7, v3, 5, s44
    v_add_u32 v38, s45, v2
    s_lshr_b32 s45, s3, 1
    s_cmp_lg_u32 s3, 2
    s_cbranch_scc1 L_do_ln
    s_waitcnt lgkmcnt(0)
    s_mul_i32 s47, s46, 0x9e3779b1
    s_add_u32 s47, s47, 0x7f4a7c15
    s_and_b32 s44, s30, 7
    s_cmp_lg_u32 s44, 0
    s_cbranch_scc1 L_noxf
    s_getreg_b32 s44, hwreg(HW_REG_XCC_ID, 0, 4)
    s_xor_b32 s44, s44, s47
    v_mov_b32 v100, s44
    v_mov_b32 v101, s44
    v_mov_b32 v102, s44
    v_mov_b32 v103, s44
    s_lshl_b32 s44, s31, 7
    s_lshl1_add_u32 s44, s30, s44
    s_add_u32 s44, s44, 262144
    s_mov_b64 exec, 1
    buffer_store_dwordx4 v[100:103], v1, s[52:55], s44 offen sc1
    s_mov_b64 exec, -1
L_noxf:
    s_cmp_ge_u32 s63, 172
    s_cbranch_scc1 L_m1_done
L_do_ln:
    s_waitcnt vmcnt(8)
L_ln:
    v_lshlrev_b32 v12, 16, v8
    v_and_b32 v13, 0xffff0000, v8
    v_lshlrev_b32 v14, 16, v9
    v_and_b32 v15, 0xffff0000, v9
    v_lshlrev_b32 v16, 16, v10
    v_and_b32 v17, 0xffff0000, v10
    v_lshlrev_b32 v18, 16, v11
    v_and_b32 v19, 0xffff0000, v11
    v_add_f32 v20, v12, v13
    v_add_f32 v21, v14, v15
    v_add_f32 v22, v16, v17
    v_add_f32 v23, v18, v19
    v_add_f32 v20, v20, v21
    v_add_f32 v22, v22, v23
    v_add_f32 v20, v20, v22
    s_nop 1
    v_add_f32_dpp v20, v20, v20 row_ror:8 row_mask:0xf bank_mask:0xf
    s_nop 1
    v_add_f32_dpp v20, v20, v20 row_ror:4 row_mask:0xf bank_mask:0xf
    s_nop 1
    v_add_f32_dpp v20, v20, v20 row_ror:2 row_mask:0xf bank_mask:0xf
    s_nop 1
    v_add_f32_dpp v20, v20, v20 row_ror:1 row_mask:0xf bank_mask:0xf
    v_mov_b32 v21, v20
    s_nop 1
    v_permlane16_swap_b32 v20, v21
    v_add_f32 v20, v20, v21
    v_mov_b32 v21, v20
    s_nop 1
    v_permlane32_swap_b32 v20, v21
    v_add_f32 v20, v20, v21
    v_mul_f32 v20, 0x3b000000, v20
    v_sub_f32 v24, v12, v20
    v_sub_f32 v25, v13, v20
    v_sub_f32 v26, v14, v20
    v_sub_f32 v27, v15, v20
    v_sub_f32 v28, v16, v20
    v_sub_f32 v29, v17, v20
    v_sub_f32 v30, v18, v20
    v_sub_f32 v31, v19, v20
    v_mul_f32 v22, v24, v24
    v_mul_f32 v23, v25, v25
    v_fmac_f32 v22, v26, v26
    v_fmac_f32 v23, v27, v27
    v_fmac_f32 v22, v28, v28
    v_fmac_f32 v23, v29, v29
    v_fmac_f32 v22, v30, v30
    v_fmac_f32 v23, v31, v31
    v_add_f32 v22, v22, v23
    v_cvt_pk_bf16_f32 v20, v20, v20
    v_and_b32 v20, 0xffff0000, v20
    v_add_f32_dpp v22, v22, v22 row_ror:8 row_mask:0xf bank_mask:0xf
    s_nop 1
    v_add_f32_dpp v22, v22, v22 row_ror:4 row_mask:0xf bank_mask:0xf
    s_nop 1
    v_add_f32_dpp v22, v22, v22 row_ror:2 row_mask:0xf bank_mask:0xf
    s_nop 1
    v_add_f32_dpp v22, v22, v22 row_ror:1 row_mask:0xf bank_mask:0xf
    v_mov_b32 v21, v22
    s_nop 1
    v_permlane16_swap_b32 v22, v21
    v_add_f32 v22, v22, v21
    v_mov_b32 v21, v22
    s_nop 1
    v_permlane32_swap_b32 v22, v21
    v_add_f32 v22, v22, v21
    v_mul_f32 v22, 0x3b000000, v22
    v_cvt_pk_bf16_f32 v22, v22, v22
    v_and_b32 v22, 0xffff0000, v22
    v_add_f32 v22, 0x3727c5ac, v22
    v_cvt_pk_bf16_f32 v22, v22, v22
    v_and_b32 v22, 0xffff0000, v22
    v_sqrt_f32 v22, v22
    v_sub_f32 v12, v12, v20
    v_sub_f32 v13, v13, v20
    v_sub_f32 v14, v14, v20
    v_sub_f32 v15, v15, v20
    v_sub_f32 v16, v16, v20
    v_sub_f32 v17, v17, v20
    v_sub_f32 v18, v18, v20
    v_sub_f32 v19, v19, v20
    v_cvt_pk_bf16_f32 v22, v22, v22
    v_and_b32 v22, 0xffff0000, v22
    v_rcp_f32 v23, v22
    v_cvt_pk_bf16_f32 v8, v12, v13
    v_cvt_pk_bf16_f32 v9, v14, v15
    v_cvt_pk_bf16_f32 v10, v16, v17
    v_cvt_pk_bf16_f32 v11, v18, v19
    v_lshlrev_b32 v12, 16, v8
    v_and_b32 v13, 0xffff0000, v8
    v_lshlrev_b32 v14, 16, v9
    v_and_b32 v15, 0xffff0000, v9
    v_lshlrev_b32 v16, 16, v10
    v_and_b32 v17, 0xffff0000, v10
    v_lshlrev_b32 v18, 16, v11
    v_and_b32 v19, 0xffff0000, v11
    v_mul_f32 v24, v12, v23
    v_mul_f32 v25, v13, v23
    v_mul_f32 v26, v14, v23
    v_mul_f32 v27, v15, v23
    v_mul_f32 v28, v16, v23
    v_mul_f32 v29, v17, v23
    v_mul_f32 v30, v18, v23
    v_mul_f32 v31, v19, v23
    v_fma_f32 v12, -v24, v22, v12
    v_fma_f32 v13, -v25, v22, v13
    v_fma_f32 v14, -v26, v22, v14
    v_fma_f32 v15, -v27, v22, v15
    v_fma_f32 v16, -v28, v22, v16
    v_fma_f32 v17, -v29, v22, v17
    v_fma_f32 v18, -v30, v22, v18
    v_fma_f32 v19, -v31, v22, v19
    v_fma_f32 v12, v12, v23, v24
    v_fma_f32 v13, v13, v23, v25
    v_fma_f32 v14, v14, v23, v26
    v_fma_f32 v15, v15, v23, v27
    v_fma_f32 v16, v16, v23, v28
    v_fma_f32 v17, v17, v23, v29
    v_fma_f32 v18, v18, v23, v30
    v_fma_f32 v19, v19, v23, v31
    v_cvt_pk_bf16_f32 v8, v12, v13
    v_cvt_pk_bf16_f32 v9, v14, v15
    v_cvt_pk_bf16_f32 v10, v16, v17
    v_cvt_pk_bf16_f32 v11, v18, v19
    s_sub_u32 s45, s45, 1
    s_cbranch_scc0 L_ln
    ds_write_b128 v38, v[8:11] offset:0
    s_cmp_eq_u32 s3, 2
    s_cbranch_scc1 L_m1
    s_lshl_b32 s44, s3, 4
    v_add_u32 v7, s44, v7
    ds_read_b128 v[12:15], v7 offset:0
    s_mov_b32 s50, 0x01000100
    s_mov_b32 s51, 0x03020302
    s_lshl_b32 s49, s30, 11
    s_add_u32 s49, s49, 65536
    s_xor_b32 s44, s31, 1
    s_lshl_b32 s44, s44, 8
    s_add_u32 s48, s49, s44
    s_waitcnt lgkmcnt(0)
    s_mul_i32 s47, s46, 0x9e3779b1
    s_add_u32 s47, s47, 0x7f4a7c15
    v_perm_b32 v28, v12, v12, s50
    v_and_b32 v20, v28, v32
    v_and_b32 v21, v28, v33
    v_and_b32 v22, v28, v34
    v_and_b32 v23, v28, v35
    s_waitcnt vmcnt(7)
    s_nop 0
    v_mfma_f32_16x16x32_bf16 v[8:11], v[20:23], v[40:43], 0
    v_perm_b32 v28, v12, v12, s51
    v_and_b32 v24, v28, v32
    v_and_b32 v25, v28, v33
    v_and_b32 v26, v28, v34
    v_and_b32 v27, v28, v35
    s_waitcnt vmcnt(6)
    s_nop 0
    v_mfma_f32_16x16x32_bf16 v[8:11], v[24:27], v[44:47], v[8:11]
    v_perm_b32 v28, v13, v13, s50
    v_and_b32 v20, v28, v32
    v_and_b32 v21, v28, v33
    v_and_b32 v22, v28, v34
    v_and_b32 v23, v28, v35
    s_waitcnt vmcnt(5)
    s_nop 0
    v_mfma_f32_16x16x32_bf16 v[8:11], v[20:23], v[48:51], v[8:11]
    v_perm_b32 v28, v13, v13, s51
    v_and_b32 v24, v28, v32
    v_and_b32 v25, v28, v33
    v_and_b32 v26, v28, v34
    v_and_b32 v27, v28, v35
    s_waitcnt vmcnt(4)
    s_nop 0
    v_mfma_f32_16x16x32_bf16 v[8:11], v[24:27], v[52:55], v[8:11]
    v_perm_b32 v28, v14, v14, s50
    v_and_b32 v20, v28, v32
    v_and_b32 v21, v28, v33
    v_and_b32 v22, v28, v34
    v_and_b32 v23, v28, v35
    s_waitcnt vmcnt(3)
    s_nop 0
    v_mfma_f32_16x16x32_bf16 v[8:11], v[20:23], v[56:59], v[8:11]
    v_perm_b32 v28, v14, v14, s51
    v_and_b32 v24, v28, v32
    v_and_b32 v25, v28, v33
    v_and_b32 v26, v28, v34
    v_and_b32 v27, v28, v35
    s_waitcnt vmcnt(2)
    s_nop 0
    v_mfma_f32_16x16x32_bf16 v[8:11], v[24:27], v[60:63], v[8:11]
    v_perm_b32 v28, v15, v15, s50
    v_and_b32 v20, v28, v32
    v_and_b32 v21, v28, v33
    v_and_b32 v22, v28, v34
    v_and_b32 v23, v28, v35
    s_waitcnt vmcnt(1)
    s_nop 0
    v_mfma_f32_16x16x32_bf16 v[8:11], v[20:23], v[64:67], v[8:11]
    v_perm_b32 v28, v15, v15, s51
    v_and_b32 v24, v28, v32
    v_and_b32 v25, v28, v33
    v_and_b32 v26, v28, v34
    v_and_b32 v27, v28, v35
    s_waitcnt vmcnt(0)
    s_nop 0
    v_mfma_f32_16x16x32_bf16 v[8:11], v[24:27], v[68:71], v[8:11]
    s_nop 7
    v_permlane32_swap_b32 v8, v10
    v_permlane32_swap_b32 v9, v11
    s_nop 0
    v_add_f32_dpp v8, v10, v8 row_ror:8 row_mask:0xf bank_mask:0xf
    v_add_f32_dpp v9, v11, v9 row_ror:8 row_mask:0xf bank_mask:0xf
    v_mov_b32 v13, s47
    v_mov_b32 v15, s47
    v_lshlrev_b32 v19, 3, v0
    s_cmp_eq_u32 s3, 0
    s_cbranch_scc1 L_h0
    ds_write_b64 v19, v[8:9] offset:4096
    s_mov_b64 exec, 1
    ds_add_u32 v1, v39 offset:3344
    s_mov_b64 exec, -1
    s_branch L_gemv
L_h0:
    s_and_b32 s80, s47, 0xff
    s_bfe_u32 s81, s47, 0x80008
    s_bfe_u32 s82, s47, 0x80010
    s_lshr_b32 s83, s47, 24
    s_getreg_b32 s60, hwreg(HW_REG_XCC_ID, 0, 4)
    s_xor_b32 s60, s60, s47
    s_lshl_b32 s61, s31, 7
    s_add_u32 s61, s61, 262144
    v_and_b32 v36, 3, v0
    v_lshlrev_b32 v36, 4, v36
    s_mov_b32 s45, 0
L_qh:
    ds_read_b32 v20, v1 offset:3344
    ds_read_b64 v[16:17], v19 offset:4096
    s_add_u32 s45, s45, 1
    s_waitcnt lgkmcnt(0)
    v_readfirstlane_b32 s44, v20
    s_nop 0
    s_cmp_ge_u32 s44, 1
    s_cbranch_scc1 L_qh_ok
    s_sleep 1
    s_cmp_lt_u32 s45, 3200000
    s_cbranch_scc1 L_qh
L_qh_ok:
    v_add_f32 v8, v8, v16
    v_add_f32 v9, v9, v17
    ds_bpermute_b32 v20, v98, v8
    ds_bpermute_b32 v21, v98, v9
    ds_bpermute_b32 v22, v98, v8 offset:128
    ds_bpermute_b32 v23, v98, v9 offset:128
    s_waitcnt lgkmcnt(0)
    s_movk_i32 s44, 0xff00
    v_add_u32 v20, 0x80, v20
    v_and_b32 v20, s44, v20
    v_or_b32 v20, s80, v20
    v_add_u32 v21, 0x80, v21
    v_and_b32 v21, s44, v21
    v_or_b32 v21, s81, v21
    v_add_u32 v22, 0x80, v22
    v_and_b32 v22, s44, v22
    v_or_b32 v22, s82, v22
    v_add_u32 v23, 0x80, v23
    v_and_b32 v23, s44, v23
    v_or_b32 v23, s83, v23
    s_mov_b64 exec, 0xffff
    buffer_store_dwordx4 v[20:23], v2, s[52:55], s48 offen sc1
    s_mov_b64 exec, -1
    s_waitcnt vmcnt(0)
    buffer_load_dwordx4 v[40:43], v2, s[52:55], s49 offen offset:0 sc1
    buffer_load_dwordx4 v[44:47], v2, s[52:55], s49 offen offset:1024 sc1
    buffer_load_dwordx4 v[56:59], v36, s[52:55], s61 offen sc1
    s_mov_b32 s45, 0
L_qp:
    s_waitcnt vmcnt(0)
    v_xor_b32 v16, s80, v40
    v_bitop3_b32 v16, v16, v41, s81 bitop3:0xf6
    v_bitop3_b32 v16, v16, v42, s82 bitop3:0xf6
    v_bitop3_b32 v16, v16, v43, s83 bitop3:0xf6
    v_bitop3_b32 v16, v16, v44, s80 bitop3:0xf6
    v_bitop3_b32 v16, v16, v45, s81 bitop3:0xf6
    v_bitop3_b32 v16, v16, v46, s82 bitop3:0xf6
    v_bitop3_b32 v16, v16, v47, s83 bitop3:0xf6
    v_and_b32 v16, 0xff, v16
    v_cmp_ne_u32 vcc, 0, v16
    s_nop 0
    s_cbranch_vccz L_qp_ok0
    s_sleep 8
    buffer_load_dwordx4 v[40:43], v2, s[52:55], s49 offen offset:0 sc1
    buffer_load_dwordx4 v[44:47], v2, s[52:55], s49 offen offset:1024 sc1
    buffer_load_dwordx4 v[56:59], v36, s[52:55], s61 offen sc1
    s_add_u32 s45, s45, 1
    s_cmp_lt_u32 s45, 400000
    s_cbranch_scc1 L_qp
L_qp_ok0:
L_qp_done:
    s_movk_i32 s44, 0xff00
    v_and_b32 v40, s44, v40
    v_and_b32 v41, s44, v41
    v_and_b32 v42, s44, v42
    v_and_b32 v43, s44, v43
    v_and_b32 v44, s44, v44
    v_and_b32 v45, s44, v45
    v_and_b32 v46, s44, v46
    v_and_b32 v47, s44, v47
    v_add_f32 v40, v40, v44
    v_add_f32 v41, v41, v45
    v_add_f32 v42, v42, v46
    v_add_f32 v43, v43, v47
    s_nop 0
    v_permlane32_swap_b32 v40, v42
    v_permlane32_swap_b32 v41, v43
    v_add_f32 v40, v40, v42
    v_add_f32 v41, v41, v43
    v_cvt_pk_bf16_f32 v8, v40, v41
    v_and_b32 v16, 31, v0
    v_lshlrev_b32 v16, 3, v16
    v_lshrrev_b32 v17, 5, v0
    v_lshl_add_u32 v16, v17, 2, v16
    ds_write_b32 v16, v8 offset:3072
    v_xor_b32 v17, s60, v56
    v_bitop3_b32 v17, v17, v59, s60 bitop3:0xf6
    v_cmp_ne_u32 vcc, 0, v17
    s_nop 0
    s_cmp_eq_u64 vcc, 0
    s_cselect_b32 s44, 1, 2
    v_mov_b32 v18, s44
    s_lshr_b32 s44, s31, 1
    s_mul_i32 s44, s44, 1040
    s_and_b32 s45, s31, 1
    s_lshl_b32 s45, s45, 9
    s_add_u32 s44, s44, s45
    v_and_b32 v16, 31, v0
    v_lshl_add_u32 v16, v16, 4, s44
    v_not_b32 v17, v13
    ds_write_b32 v16, v17 offset:24588
    ds_write_b32 v16, v17 offset:28748
    ds_write_b32 v16, v17 offset:32908
    ds_write_b32 v16, v17 offset:37068
    ds_write_b32 v1, v18 offset:3340
L_gemv:
    v_lshrrev_b32 v16, 4, v0
    v_bfe_u32 v17, v0, 2, 2
    v_lshlrev_b32 v18, 12, v16
    v_lshl_add_u32 v18, v17, 7, v18
    v_and_b32 v19, 3, v0
    v_lshl_add_u32 v18, v19, 3, v18
    v_lshrrev_b32 v17, 1, v17
    v_and_b32 v19, 1, v16
    v_lshl_or_b32 v17, v19, 1, v17
    s_lshl_b32 s44, s3, 1
    v_xor_b32 v17, s44, v17
    v_lshl_add_u32 v20, v17, 5, v18
    v_xor_b32 v17, 1, v17
    v_lshl_add_u32 v21, v17, 5, v18
    s_mul_i32 s60, s3, 8320
    s_add_u32 s60, s60, 24576
    v_lshrrev_b32 v19, 1, v4
    v_mul_u32_u24 v36, 1040, v19
    v_and_b32 v19, 1, v4
    v_lshl_add_u32 v36, v19, 9, v36
    v_add_u32 v36, s60, v36
    v_lshl_add_u32 v22, v16, 6, v36
    v_add_u32 v37, s60, v2
    s_lshl_b32 s50, s30, 12
    s_add_u32 s50, s50, 524288
    s_add_u32 s56, s50, 0
    s_add_u32 s57, s50, 1024
    s_add_u32 s58, s50, 2048
    s_add_u32 s59, s50, 3072
    v_lshl_add_u32 v23, v16, 3, v4
    v_lshlrev_b32 v23, 4, v23
    s_lshl_b32 s48, s31, 14
    s_lshl_b32 s44, s30, 9
    s_add_u32 s48, s48, s44
    s_lshl_b32 s44, s3, 8
    s_add_u32 s49, s48, s44
    s_add_u32 s49, s49, 1048576
    s_cmp_eq_u32 s31, 0
    s_cselect_b32 s88, 0, -1
    s_cmp_eq_u32 s31, 1
    s_cselect_b32 s89, 0, -1
    s_cmp_eq_u32 s31, 2
    s_cselect_b32 s90, 0, -1
    s_cmp_eq_u32 s31, 3
    s_cselect_b32 s91, 0, -1
    s_cmp_eq_u32 s31, 4
    s_cselect_b32 s92, 0, -1
    s_cmp_eq_u32 s31, 5
    s_cselect_b32 s93, 0, -1
    s_cmp_eq_u32 s31, 6
    s_cselect_b32 s94, 0, -1
    s_cmp_eq_u32 s31, 7
    s_cselect_b32 s95, 0, -1
    s_mov_b32 s45, 0
L_go:
    ds_read_b32 v16, v1 offset:3332
    ds_read_b32 v17, v1 offset:3340
    s_add_u32 s45, s45, 1
    s_waitcnt lgkmcnt(0)
    v_readfirstlane_b32 s44, v16
    s_nop 0
    s_cmp_ge_u32 s44, 8
    s_cbranch_scc1 L_go_ok
    s_sleep 1
    s_cmp_lt_u32 s45, 3200000
    s_cbranch_scc1 L_go
L_go_ok:
    v_readfirstlane_b32 s85, v17
    s_add_u32 m0, s60, 0
    s_mov_b64 exec, s[88:89]
    buffer_load_dwordx4 v2, s[52:55], s56 offen sc1 lds
    s_add_u32 m0, s60, 1040
    s_mov_b64 exec, s[90:91]
    buffer_load_dwordx4 v2, s[52:55], s57 offen sc1 lds
    s_add_u32 m0, s60, 2080
    s_mov_b64 exec, s[92:93]
    buffer_load_dwordx4 v2, s[52:55], s58 offen sc1 lds
    s_add_u32 m0, s60, 3120
    s_mov_b64 exec, s[94:95]
    buffer_load_dwordx4 v2, s[52:55], s59 offen sc1 lds
    s_mov_b64 exec, -1
    s_mov_b32 s45, 0
L_wo:
    ds_read_b32 v16, v1 offset:3336
    s_add_u32 s45, s45, 1
    s_waitcnt lgkmcnt(0)
    v_readfirstlane_b32 s44, v16
    s_nop 0
    s_cmp_ge_u32 s44, 4
    s_cbranch_scc1 L_wo_ok
    s_cmp_lt_u32 s45, 3200000
    s_cbranch_scc1 L_wo
L_wo_ok:
    s_add_u32 m0, s60, 4160
    s_mov_b64 exec, s[88:89]
    buffer_load_dwordx4 v2, s[52:55], s56 offen sc1 lds
    s_add_u32 m0, s60, 5200
    s_mov_b64 exec, s[90:91]
    buffer_load_dwordx4 v2, s[52:55], s57 offen sc1 lds
    s_add_u32 m0, s60, 6240
    s_mov_b64 exec, s[92:93]
    buffer_load_dwordx4 v2, s[52:55], s58 offen sc1 lds
    s_add_u32 m0, s60, 7280
    s_mov_b64 exec, s[94:95]
    buffer_load_dwordx4 v2, s[52:55], s59 offen sc1 lds
    s_mov_b64 exec, -1
    ds_read_b64_tr_b16 v[120:121], v20 offset:8192
    ds_read_b64_tr_b16 v[122:123], v20 offset:8704
    ds_read_b64_tr_b16 v[124:125], v21 offset:8192
    ds_read_b64_tr_b16 v[126:127], v21 offset:8704
    ds_read_b64_tr_b16 v[128:129], v20 offset:9216
    ds_read_b64_tr_b16 v[130:131], v20 offset:9728
    ds_read_b64_tr_b16 v[132:133], v21 offset:9216
    ds_read_b64_tr_b16 v[134:135], v21 offset:9728
    ds_read_b64_tr_b16 v[136:137], v20 offset:10240
    ds_read_b64_tr_b16 v[138:139], v20 offset:10752
    ds_read_b64_tr_b16 v[140:141], v21 offset:10240
    ds_read_b64_tr_b16 v[142:143], v21 offset:10752
    ds_read_b64_tr_b16 v[144:145], v20 offset:11264
    ds_read_b64_tr_b16 v[146:147], v20 offset:11776
    ds_read_b64_tr_b16 v[148:149], v21 offset:11264
    ds_read_b64_tr_b16 v[150:151], v21 offset:11776
    s_mov_b32 s45, 0
L_op:
    s_waitcnt vmcnt(4)
    ds_read_b32 v100, v37 offset:12
    ds_read_b32 v101, v37 offset:1052
    ds_read_b32 v102, v37 offset:2092
    ds_read_b32 v103, v37 offset:3132
    ds_read_b32 v8, v36 offset:8
    ds_read_b32 v10, v36 offset:24
    ds_read_b64 v[104:105], v22 offset:0
    ds_read_b64 v[106:107], v22 offset:256
    ds_read_b64 v[108:109], v22 offset:16
    ds_read_b64 v[110:111], v22 offset:272
    ds_read_b64 v[112:113], v22 offset:32
    ds_read_b64 v[114:115], v22 offset:288
    ds_read_b64 v[116:117], v22 offset:48
    ds_read_b64 v[118:119], v22 offset:304
    s_waitcnt lgkmcnt(10)
    v_xor_b32 v16, s47, v100
    v_bitop3_b32 v16, v16, v101, s47 bitop3:0xf6
    v_bitop3_b32 v16, v16, v102, s47 bitop3:0xf6
    v_bitop3_b32 v16, v16, v103, s47 bitop3:0xf6
    v_cmp_ne_u32 vcc, 0, v16
    s_nop 0
    s_cbranch_vccz L_op_ok0
    s_waitcnt lgkmcnt(0)
    s_add_u32 m0, s60, 0
    s_mov_b64 exec, s[88:89]
    buffer_load_dwordx4 v2, s[52:55], s56 offen sc1 lds
    s_add_u32 m0, s60, 1040
    s_mov_b64 exec, s[90:91]
    buffer_load_dwordx4 v2, s[52:55], s57 offen sc1 lds
    s_add_u32 m0, s60, 2080
    s_mov_b64 exec, s[92:93]
    buffer_load_dwordx4 v2, s[52:55], s58 offen sc1 lds
    s_add_u32 m0, s60, 3120
    s_mov_b64 exec, s[94:95]
    buffer_load_dwordx4 v2, s[52:55], s59 offen sc1 lds
    s_mov_b64 exec, -1
    s_waitcnt vmcnt(4)
    ds_read_b32 v100, v37 offset:4172
    ds_read_b32 v101, v37 offset:5212
    ds_read_b32 v102, v37 offset:6252
    ds_read_b32 v103, v37 offset:7292
    ds_read_b32 v8, v36 offset:4168
    ds_read_b32 v10, v36 offset:4184
    ds_read_b64 v[104:105], v22 offset:4160
    ds_read_b64 v[106:107], v22 offset:4416
    ds_read_b64 v[108:109], v22 offset:4176
    ds_read_b64 v[110:111], v22 offset:4432
    ds_read_b64 v[112:113], v22 offset:4192
    ds_read_b64 v[114:115], v22 offset:4448
    ds_read_b64 v[116:117], v22 offset:4208
    ds_read_b64 v[118:119], v22 offset:4464
    s_waitcnt lgkmcnt(10)
    v_xor_b32 v16, s47, v100
    v_bitop3_b32 v16, v16, v101, s47 bitop3:0xf6
    v_bitop3_b32 v16, v16, v102, s47 bitop3:0xf6
    v_bitop3_b32 v16, v16, v103, s47 bitop3:0xf6
    v_cmp_ne_u32 vcc, 0, v16
    s_nop 0
    s_cbranch_vccz L_op_ok1
    s_waitcnt lgkmcnt(0)
    s_add_u32 m0, s60, 4160
    s_mov_b64 exec, s[88:89]
    buffer_load_dwordx4 v2, s[52:55], s56 offen sc1 lds
    s_add_u32 m0, s60, 5200
    s_mov_b64 exec, s[90:91]
    buffer_load_dwordx4 v2, s[52:55], s57 offen sc1 lds
    s_add_u32 m0, s60, 6240
    s_mov_b64 exec, s[92:93]
    buffer_load_dwordx4 v2, s[52:55], s58 offen sc1 lds
    s_add_u32 m0, s60, 7280
    s_mov_b64 exec, s[94:95]
    buffer_load_dwordx4 v2, s[52:55], s59 offen sc1 lds
    s_mov_b64 exec, -1
    s_add_u32 s45, s45, 1
    s_cmp_lt_u32 s45, 400000
    s_cbranch_scc1 L_op
L_op_ok0:
L_op_ok1:
L_op_done:
    s_waitcnt lgkmcnt(8)
    v_max_f32_dpp v9, v8, v8 quad_perm:[1,0,3,2] row_mask:0xf bank_mask:0xf
    s_waitcnt lgkmcnt(6)
    v_mfma_f32_16x16x32_bf16 v[24:27], v[104:107], v[120:123], 0
    v_max_f32_dpp v9, v9, v9 quad_perm:[2,3,0,1] row_mask:0xf bank_mask:0xf
    v_mfma_f32_16x16x32_bf16 v[28:31], v[104:107], v[124:127], 0
    s_waitcnt lgkmcnt(4)
    v_max_f32_dpp v9, v9, v9 row_half_mirror row_mask:0xf bank_mask:0xf
    v_mfma_f32_16x16x32_bf16 v[24:27], v[108:111], v[128:131], v[24:27]
    v_sub_f32 v8, v8, v9
    v_mul_f32 v8, 0x3fb8aa3b, v8
    v_exp_f32 v8, v8
    v_mfma_f32_16x16x32_bf16 v[28:31], v[108:111], v[132:135], v[28:31]
    s_waitcnt lgkmcnt(2)
    v_mul_f32 v10, v8, v10
    v_mfma_f32_16x16x32_bf16 v[24:27], v[112:115], v[136:139], v[24:27]
    v_mov_b32_dpp v32, v8 row_newbcast:0 row_mask:0x5 bank_mask:0xf
    v_add_f32_dpp v10, v10, v10 quad_perm:[1,0,3,2] row_mask:0xf bank_mask:0xf
    v_mfma_f32_16x16x32_bf16 v[28:31], v[112:115], v[140:143], v[28:31]
    s_waitcnt lgkmcnt(0)
    v_add_f32_dpp v10, v10, v10 quad_perm:[2,3,0,1] row_mask:0xf bank_mask:0xf
    v_mfma_f32_16x16x32_bf16 v[24:27], v[116:119], v[144:147], v[24:27]
    v_mov_b32_dpp v33, v8 row_newbcast:1 row_mask:0x5 bank_mask:0xf
    v_add_f32_dpp v10, v10, v10 row_half_mirror row_mask:0xf bank_mask:0xf
    v_mfma_f32_16x16x32_bf16 v[28:31], v[116:119], v[148:151], v[28:31]
    v_mov_b32_dpp v34, v8 row_newbcast:2 row_mask:0x5 bank_mask:0xf
    v_mov_b32_dpp v35, v8 row_newbcast:3 row_mask:0x5 bank_mask:0xf
    v_mov_b32_dpp v32, v8 row_newbcast:4 row_mask:0xa bank_mask:0xf
    v_mov_b32_dpp v33, v8 row_newbcast:5 row_mask:0xa bank_mask:0xf
    v_mov_b32_dpp v34, v8 row_newbcast:6 row_mask:0xa bank_mask:0xf
    v_mov_b32_dpp v35, v8 row_newbcast:7 row_mask:0xa bank_mask:0xf
    v_rcp_f32 v10, v10
    s_cmp_eq_u32 s85, 1
    v_pk_mul_f32 v[24:25], v[24:25], v[32:33]
    v_pk_mul_f32 v[28:29], v[28:29], v[32:33]
    v_pk_fma_f32 v[24:25], v[26:27], v[34:35], v[24:25]
    v_pk_fma_f32 v[28:29], v[30:31], v[34:35], v[28:29]
    v_add_f32 v24, v24, v25
    v_add_f32 v28, v28, v29
    s_nop 1
    v_permlane16_swap_b32 v24, v28
    v_add_f32 v12, v24, v28
    v_mul_f32 v12, v12, v10
    s_nop 1
    v_mov_b32_dpp v14, v12 row_ror:8 row_mask:0xf bank_mask:0xf
    s_mov_b64 exec, 0x00ff00ff
    s_cbranch_scc0 L_tp_s
    buffer_store_dwordx4 v[12:15], v23, s[52:55], s49 offen
    s_branch L_tp_d
L_tp_s:
    buffer_store_dwordx4 v[12:15], v23, s[52:55], s49 offen sc1
L_tp_d:
    s_mov_b64 exec, 1
    ds_add_u32 v1, v39 offset:3348
    s_branch L_fin
L_m1:
    ds_read_b128 v[12:15], v7 offset:0
    ds_read_b128 v[16:19], v7 offset:16
    s_lshl_b32 s44, s49, 6
    v_lshl_add_u32 v36, v4, 3, s44
    v_mov_b32 v37, 16
    v_cmp_lt_u32 vcc, 1375, v36
    s_nop 1
    v_cndmask_b32 v37, 0, v37, vcc
    s_mul_i32 s50, s48, 11008
    s_lshl_b32 s44, s49, 8
    s_add_u32 s50, s50, s44
    s_add_u32 s50, s50, 327680
    s_waitcnt lgkmcnt(0)
    s_mul_i32 s47, s46, 0x9e3779b1
    s_add_u32 s47, s47, 0x7f4a7c15
    v_lshrrev_b32 v12, v37, v12
    v_lshlrev_b32 v72, 16, v12
    v_and_b32 v12, 0xffff, v12
    v_lshrrev_b32 v13, v37, v13
    v_lshlrev_b32 v73, 16, v13
    v_and_b32 v13, 0xffff, v13
    v_lshrrev_b32 v14, v37, v14
    v_lshlrev_b32 v74, 16, v14
    v_and_b32 v14, 0xffff, v14
    v_lshrrev_b32 v15, v37, v15
    v_lshlrev_b32 v75, 16, v15
    v_and_b32 v15, 0xffff, v15
    v_lshrrev_b32 v16, v37, v16
    v_lshlrev_b32 v76, 16, v16
    v_and_b32 v16, 0xffff, v16
    v_lshrrev_b32 v17, v37, v17
    v_lshlrev_b32 v77, 16, v17
    v_and_b32 v17, 0xffff, v17
    v_lshrrev_b32 v18, v37, v18
    v_lshlrev_b32 v78, 16, v18
    v_and_b32 v18, 0xffff, v18
    v_lshrrev_b32 v19, v37, v19
    v_lshlrev_b32 v79, 16, v19
    v_and_b32 v19, 0xffff, v19
    s_waitcnt vmcnt(0)
    v_dot2_f32_bf16 v20, v40, v12, 0
    v_dot2_f32_bf16 v21, v40, v72, 0
    v_dot2_f32_bf16 v22, v41, v12, 0
    v_dot2_f32_bf16 v23, v41, v72, 0
    v_dot2_f32_bf16 v24, v42, v12, 0
    v_dot2_f32_bf16 v25, v42, v72, 0
    v_dot2_f32_bf16 v26, v43, v12, 0
    v_dot2_f32_bf16 v27, v43, v72, 0
    v_dot2_f32_bf16 v20, v44, v13, v20
    v_dot2_f32_bf16 v21, v44, v73, v21
    v_dot2_f32_bf16 v22, v45, v13, v22
    v_dot2_f32_bf16 v23, v45, v73, v23
    v_dot2_f32_bf16 v24, v46, v13, v24
    v_dot2_f32_bf16 v25, v46, v73, v25
    v_dot2_f32_bf16 v26, v47, v13, v26
    v_dot2_f32_bf16 v27, v47, v73, v27
    v_dot2_f32_bf16 v20, v48, v14, v20
    v_dot2_f32_bf16 v21, v48, v74, v21
    v_dot2_f32_bf16 v22, v49, v14, v22
    v_dot2_f32_bf16 v23, v49, v74, v23
    v_dot2_f32_bf16 v24, v50, v14, v24
    v_dot2_f32_bf16 v25, v50, v74, v25
    v_dot2_f32_bf16 v26, v51, v14, v26
    v_dot2_f32_bf16 v27, v51, v74, v27
    v_dot2_f32_bf16 v20, v52, v15, v20
    v_dot2_f32_bf16 v21, v52, v75, v21
    v_dot2_f32_bf16 v22, v53, v15, v22
    v_dot2_f32_bf16 v23, v53, v75, v23
    v_dot2_f32_bf16 v24, v54, v15, v24
    v_dot2_f32_bf16 v25, v54, v75, v25
    v_dot2_f32_bf16 v26, v55, v15, v26
    v_dot2_f32_bf16 v27, v55, v75, v27
    v_dot2_f32_bf16 v20, v56, v16, v20
    v_dot2_f32_bf16 v21, v56, v76, v21
    v_dot2_f32_bf16 v22, v57, v16, v22
    v_dot2_f32_bf16 v23, v57, v76, v23
    v_dot2_f32_bf16 v24, v58, v16, v24
    v_dot2_f32_bf16 v25, v58, v76, v25
    v_dot2_f32_bf16 v26, v59, v16, v26
    v_dot2_f32_bf16 v27, v59, v76, v27
    v_dot2_f32_bf16 v20, v60, v17, v20
    v_dot2_f32_bf16 v21, v60, v77, v21
    v_dot2_f32_bf16 v22, v61, v17, v22
    v_dot2_f32_bf16 v23, v61, v77, v23
    v_dot2_f32_bf16 v24, v62, v17, v24
    v_dot2_f32_bf16 v25, v62, v77, v25
    v_dot2_f32_bf16 v26, v63, v17, v26
    v_dot2_f32_bf16 v27, v63, v77, v27
    v_dot2_f32_bf16 v20, v64, v18, v20
    v_dot2_f32_bf16 v21, v64, v78, v21
    v_dot2_f32_bf16 v22, v65, v18, v22
    v_dot2_f32_bf16 v23, v65, v78, v23
    v_dot2_f32_bf16 v24, v66, v18, v24
    v_dot2_f32_bf16 v25, v66, v78, v25
    v_dot2_f32_bf16 v26, v67, v18, v26
    v_dot2_f32_bf16 v27, v67, v78, v27
    v_dot2_f32_bf16 v20, v68, v19, v20
    v_dot2_f32_bf16 v21, v68, v79, v21
    v_dot2_f32_bf16 v22, v69, v19, v22
    v_dot2_f32_bf16 v23, v69, v79, v23
    v_dot2_f32_bf16 v24, v70, v19, v24
    v_dot2_f32_bf16 v25, v70, v79, v25
    v_dot2_f32_bf16 v26, v71, v19, v26
    v_dot2_f32_bf16 v27, v71, v79, v27
    v_permlane32_swap_b32 v20, v22
    v_permlane32_swap_b32 v21, v23
    v_permlane32_swap_b32 v24, v26
    v_permlane32_swap_b32 v25, v27
    v_add_f32 v20, v20, v22
    v_add_f32 v21, v21, v23
    v_add_f32 v24, v24, v26
    v_add_f32 v25, v25, v27
    s_nop 0
    v_permlane16_swap_b32 v20, v24
    v_permlane16_swap_b32 v21, v25
    v_add_f32 v20, v20, v24
    v_add_f32 v21, v21, v25
    s_nop 0
    v_add_f32_dpp v20, v20, v20 row_ror:8 row_mask:0xf bank_mask:0xf
    v_add_f32_dpp v21, v21, v21 row_ror:8 row_mask:0xf bank_mask:0xf
    s_and_b32 s80, s47, 0xff
    s_bfe_u32 s81, s47, 0x80008
    s_bfe_u32 s82, s47, 0x80010
    s_lshr_b32 s83, s47, 24
    ds_bpermute_b32 v12, v98, v20
    ds_bpermute_b32 v13, v98, v21
    ds_bpermute_b32 v14, v98, v20 offset:128
    ds_bpermute_b32 v15, v98, v21 offset:128
    s_waitcnt lgkmcnt(0)
    s_movk_i32 s44, 0xff00
    v_add_u32 v12, 0x80, v12
    v_and_b32 v12, s44, v12
    v_or_b32 v12, s80, v12
    v_add_u32 v13, 0x80, v13
    v_and_b32 v13, s44, v13
    v_or_b32 v13, s81, v13
    v_add_u32 v14, 0x80, v14
    v_and_b32 v14, s44, v14
    v_or_b32 v14, s82, v14
    v_add_u32 v15, 0x80, v15
    v_and_b32 v15, s44, v15
    v_or_b32 v15, s83, v15
    s_mov_b64 exec, 0xffff
    buffer_store_dwordx4 v[12:15], v2, s[52:55], s50 offen sc1
    s_mov_b64 exec, -1
L_m1_done:
    s_and_b32 s44, s30, 7
    s_cmp_lg_u32 s44, 0
    s_cbranch_scc1 L_fin
    s_mov_b32 s32, s4
    s_mov_b32 s33, s5
    s_mov_b32 s34, 1024
    s_mov_b32 s35, 0x20000
    s_mov_b32 s40, s24
    s_mov_b32 s41, s25
    s_mov_b32 s42, 1024
    s_mov_b32 s43, 0x20000
    s_lshl_b32 s48, s31, 14
    s_lshl_b32 s44, s30, 4
    s_add_u32 s48, s48, s44
    s_lshl_b32 s44, s31, 7
    s_lshl_b32 s45, s30, 2
    s_add_u32 s44, s44, s45
    v_bfe_u32 v20, v0, 4, 1
    v_lshl_add_u32 v21, v20, 3, v4
    v_lshl_add_u32 v5, v21, 1, s44
    buffer_load_ushort v36, v5, s[32:35], 0 offen
    v_lshlrev_b32 v21, 2, v21
    v_lshlrev_b32 v7, 9, v3
    v_lshl_add_u32 v7, v4, 4, v7
    s_add_u32 s56, s48, 1048576
    s_add_u32 s57, s48, 1052672
    s_add_u32 s58, s48, 1056768
    s_add_u32 s59, s48, 1060864
    buffer_load_dwordx4 v[56:59], v7, s[52:55], s56 offen sc1
    buffer_load_dwordx4 v[60:63], v7, s[52:55], s57 offen sc1
    buffer_load_dwordx4 v[64:67], v7, s[52:55], s58 offen sc1
    buffer_load_dwordx4 v[68:71], v7, s[52:55], s59 offen sc1
    s_waitcnt vmcnt(0)
    v_lshlrev_b32 v36, 16, v36
    s_mov_b32 s45, 0
L_gt0:
    ds_read_b32 v18, v1 offset:3356
    ds_read_b32 v38, v21 offset:3712
    s_add_u32 s45, s45, 1
    s_waitcnt lgkmcnt(0)
    v_readfirstlane_b32 s44, v18
    s_nop 0
    s_cmp_ge_u32 s44, 1
    s_cbranch_scc1 L_gt0_ok
    s_sleep 1
    s_cmp_lt_u32 s45, 3200000
    s_cbranch_scc1 L_gt0
L_gt0_ok:
    s_mov_b32 s45, 0
L_fw:
    ds_read_b32 v18, v1 offset:3348
    s_add_u32 s45, s45, 1
    s_waitcnt lgkmcnt(0)
    v_readfirstlane_b32 s44, v18
    s_nop 0
    s_cmp_ge_u32 s44, 1
    s_cbranch_scc1 L_fw_ok
    s_sleep 1
    s_cmp_lt_u32 s45, 3200000
    s_cbranch_scc1 L_fw
L_fw_ok:
    buffer_load_dwordx4 v[56:59], v7, s[52:55], s56 offen sc1
    buffer_load_dwordx4 v[60:63], v7, s[52:55], s57 offen sc1
    buffer_load_dwordx4 v[64:67], v7, s[52:55], s58 offen sc1
    buffer_load_dwordx4 v[68:71], v7, s[52:55], s59 offen sc1
    buffer_load_dwordx4 v[72:75], v7, s[52:55], s56 offen sc1
    buffer_load_dwordx4 v[76:79], v7, s[52:55], s57 offen sc1
    buffer_load_dwordx4 v[80:83], v7, s[52:55], s58 offen sc1
    buffer_load_dwordx4 v[84:87], v7, s[52:55], s59 offen sc1
    s_mov_b32 s45, 0
L_tp:
    s_waitcnt vmcnt(4)
    v_xor_b32 v16, s47, v57
    v_bitop3_b32 v16, v16, v59, s47 bitop3:0xf6
    v_bitop3_b32 v16, v16, v61, s47 bitop3:0xf6
    v_bitop3_b32 v16, v16, v63, s47 bitop3:0xf6
    v_bitop3_b32 v16, v16, v65, s47 bitop3:0xf6
    v_bitop3_b32 v16, v16, v67, s47 bitop3:0xf6
    v_bitop3_b32 v16, v16, v69, s47 bitop3:0xf6
    v_bitop3_b32 v16, v16, v71, s47 bitop3:0xf6
    v_cmp_ne_u32 vcc, 0, v16
    s_nop 0
    s_cbranch_vccz L_tp_ok0
    buffer_load_dwordx4 v[56:59], v7, s[52:55], s56 offen sc1
    buffer_load_dwordx4 v[60:63], v7, s[52:55], s57 offen sc1
    buffer_load_dwordx4 v[64:67], v7, s[52:55], s58 offen sc1
    buffer_load_dwordx4 v[68:71], v7, s[52:55], s59 offen sc1
    s_waitcnt vmcnt(4)
    v_xor_b32 v16, s47, v73
    v_bitop3_b32 v16, v16, v75, s47 bitop3:0xf6
    v_bitop3_b32 v16, v16, v77, s47 bitop3:0xf6
    v_bitop3_b32 v16, v16, v79, s47 bitop3:0xf6
    v_bitop3_b32 v16, v16, v81, s47 bitop3:0xf6
    v_bitop3_b32 v16, v16, v83, s47 bitop3:0xf6
    v_bitop3_b32 v16, v16, v85, s47 bitop3:0xf6
    v_bitop3_b32 v16, v16, v87, s47 bitop3:0xf6
    v_cmp_ne_u32 vcc, 0, v16
    s_nop 0
    s_cbranch_vccz L_tp_ok1
    buffer_load_dwordx4 v[72:75], v7, s[52:55], s56 offen sc1
    buffer_load_dwordx4 v[76:79], v7, s[52:55], s57 offen sc1
    buffer_load_dwordx4 v[80:83], v7, s[52:55], s58 offen sc1
    buffer_load_dwordx4 v[84:87], v7, s[52:55], s59 offen sc1
    s_add_u32 s45, s45, 1
    s_cmp_lt_u32 s45, 400000
    s_cbranch_scc1 L_tp
L_tp_ok0:
    v_add_f32 v8, v56, v60
    v_add_f32 v9, v58, v62
    v_add_f32 v10, v64, v68
    v_add_f32 v11, v66, v70
    s_branch L_tp_done
L_tp_ok1:
    v_add_f32 v8, v72, v76
    v_add_f32 v9, v74, v78
    v_add_f32 v10, v80, v84
    v_add_f32 v11, v82, v86
L_tp_done:
    v_add_f32 v8, v8, v10
    v_add_f32 v9, v9, v11
    s_nop 0
    v_add_f32_dpp v8, v8, v8 row_ror:8 row_mask:0xf bank_mask:0xf
    v_add_f32_dpp v9, v9, v9 row_ror:8 row_mask:0xf bank_mask:0xf
    s_nop 1
    v_permlane16_swap_b32 v8, v9
    v_add_f32 v8, v8, v9
    v_mov_b32 v9, v8
    s_nop 1
    v_permlane32_swap_b32 v8, v9
    v_add_f32 v8, v8, v9
    v_cvt_pk_bf16_f32 v8, v8, v8
    v_and_b32 v8, 0xffff0000, v8
    v_mul_f32 v8, v8, v38
    v_cvt_pk_bf16_f32 v8, v8, v8
    v_and_b32 v8, 0xffff0000, v8
    v_add_f32 v8, v8, v36
    v_cvt_pk_bf16_f32 v8, v8, v8
    s_mov_b64 exec, 0x00ff00ff
    buffer_store_short v8, v5, s[40:43], 0 offen
    s_cmp_lg_u32 s2, 0
    s_cbranch_scc1 L_fin
    s_add_u32 s46, s46, 1
    v_mov_b32 v8, s46
    s_mov_b64 exec, 1
    buffer_store_dword v8, v1, s[52:55], 0 offen
    s_branch L_fin
L_m2:
    s_cmp_ge_u32 s30, 29
    s_cbranch_scc1 L_fin
    v_lshrrev_b32 v7, 4, v0
    v_mul_u32_u24 v7, 5504, v7
    v_and_b32 v36, 15, v0
    v_lshl_add_u32 v7, v36, 4, v7
    s_lshl_b32 s49, s48, 2
    s_add_u32 s49, s49, 327680
    s_add_u32 s50, s49, 22016
    s_mov_b32 s60, 0x0fff0fff
    s_cmp_eq_u32 s30, 28
    s_cselect_b32 s60, 0x00ff00ff, s60
    s_mov_b32 s61, s60
    v_mov_b32 v40, 0
    v_mov_b32 v41, 0
    v_mov_b32 v42, 0
    v_mov_b32 v43, 0
    v_mov_b32 v44, 0
    v_mov_b32 v45, 0
    v_mov_b32 v46, 0
    v_mov_b32 v47, 0
    s_mov_b32 s45, 0
L_m2q:
    ds_read_b32 v16, v1 offset:3328
    s_add_u32 s45, s45, 1
    s_waitcnt lgkmcnt(0)
    v_readfirstlane_b32 s44, v16
    s_nop 0
    s_cmp_ge_u32 s44, 1
    s_cbranch_scc1 L_m2q_ok
    s_sleep 4
    s_cmp_lt_u32 s45, 3200000
    s_cbranch_scc1 L_m2q
L_m2q_ok:
    s_mul_i32 s47, s46, 0x9e3779b1
    s_add_u32 s47, s47, 0x7f4a7c15
    s_and_b32 s80, s47, 0xff
    s_bfe_u32 s81, s47, 0x80008
    s_bfe_u32 s82, s47, 0x80010
    s_lshr_b32 s83, s47, 24
    s_mov_b64 exec, s[60:61]
    buffer_load_dwordx4 v[40:43], v7, s[52:55], s49 offen sc1
    buffer_load_dwordx4 v[44:47], v7, s[52:55], s50 offen sc1
    s_mov_b32 s45, 0
L_hp:
    s_waitcnt vmcnt(0)
    v_xor_b32 v16, s80, v40
    v_bitop3_b32 v16, v16, v41, s81 bitop3:0xf6
    v_bitop3_b32 v16, v16, v42, s82 bitop3:0xf6
    v_bitop3_b32 v16, v16, v43, s83 bitop3:0xf6
    v_bitop3_b32 v16, v16, v44, s80 bitop3:0xf6
    v_bitop3_b32 v16, v16, v45, s81 bitop3:0xf6
    v_bitop3_b32 v16, v16, v46, s82 bitop3:0xf6
    v_bitop3_b32 v16, v16, v47, s83 bitop3:0xf6
    v_and_b32 v16, 0xff, v16
    v_cmp_ne_u32 vcc, 0, v16
    s_nop 0
    s_cbranch_vccz L_hp_ok0
    s_sleep 4
    buffer_load_dwordx4 v[40:43], v7, s[52:55], s49 offen sc1
    buffer_load_dwordx4 v[44:47], v7, s[52:55], s50 offen sc1
    s_add_u32 s45, s45, 1
    s_cmp_lt_u32 s45, 400000
    s_cbranch_scc1 L_hp
L_hp_ok0:
L_hp_done:
    s_mov_b64 exec, -1
    s_movk_i32 s44, 0xff00
    v_and_b32 v40, s44, v40
    v_and_b32 v41, s44, v41
    v_and_b32 v42, s44, v42
    v_and_b32 v43, s44, v43
    v_and_b32 v44, s44, v44
    v_and_b32 v45, s44, v45
    v_and_b32 v46, s44, v46
    v_and_b32 v47, s44, v47
    v_add_f32 v40, v40, v44
    v_add_f32 v41, v41, v45
    v_add_f32 v42, v42, v46
    v_add_f32 v43, v43, v47
    s_nop 0
    v_permlane32_swap_b32 v40, v42
    v_permlane32_swap_b32 v41, v43
    v_add_f32 v40, v40, v42
    v_add_f32 v41, v41, v43
    s_nop 1
    v_permlane16_swap_b32 v40, v41
    v_add_f32 v40, v40, v41
    v_cvt_pk_bf16_f32 v40, v40, v40
    v_and_b32 v40, 0xffff0000, v40
    v_lshlrev_b32 v28, 16, v28
    v_add_f32 v40, v40, v28
    v_cvt_pk_bf16_f32 v40, v40, v40
    v_and_b32 v40, 0xffff0000, v40
    v_mul_f32 v17, v40, v40
    v_mul_f32 v17, v17, v40
    v_mul_f32 v17, 0x3d372713, v17
    v_add_f32 v17, v17, v40
    v_mul_f32 v17, 0xc0135761, v17
    v_exp_f32 v17, v17
    s_nop 0
    v_add_f32 v17, 1.0, v17
    v_rcp_f32 v17, v17
    s_nop 0
    v_mul_f32 v40, v40, v17
    v_cvt_pk_bf16_f32 v40, v40, v40
    v_and_b32 v7, 3, v3
    v_lshlrev_b32 v7, 4, v7
    v_lshrrev_b32 v36, 2, v3
    v_add_u32 v7, v7, v36
    v_lshlrev_b32 v7, 2, v7
    ds_bpermute_b32 v44, v7, v40 offset:0
    ds_bpermute_b32 v45, v7, v40 offset:8
    ds_bpermute_b32 v46, v7, v40 offset:16
    ds_bpermute_b32 v47, v7, v40 offset:24
    ds_bpermute_b32 v48, v7, v40 offset:32
    ds_bpermute_b32 v49, v7, v40 offset:40
    s_waitcnt lgkmcnt(0)
    v_and_b32 v104, v44, v32
    v_and_b32 v105, v44, v33
    v_and_b32 v106, v44, v34
    v_and_b32 v107, v44, v35
    v_and_b32 v108, v45, v32
    v_and_b32 v109, v45, v33
    v_and_b32 v110, v45, v34
    v_and_b32 v111, v45, v35
    v_and_b32 v112, v46, v32
    v_and_b32 v113, v46, v33
    v_and_b32 v114, v46, v34
    v_and_b32 v115, v46, v35
    v_and_b32 v116, v47, v32
    v_and_b32 v117, v47, v33
    v_and_b32 v118, v47, v34
    v_and_b32 v119, v47, v35
    v_and_b32 v120, v48, v32
    v_and_b32 v121, v48, v33
    v_and_b32 v122, v48, v34
    v_and_b32 v123, v48, v35
    v_and_b32 v124, v49, v32
    v_and_b32 v125, v49, v33
    v_and_b32 v126, v49, v34
    v_and_b32 v127, v49, v35
    s_lshl_b32 s48, s31, 14
    s_lshl_b32 s44, s30, 9
    s_add_u32 s49, s48, s44
    s_add_u32 s49, s49, 1310720
    s_mov_b32 s40, s22
    s_mov_b32 s41, s23
    s_mov_b32 s42, 1024
    s_mov_b32 s43, 0x20000
    s_lshl_b32 s44, s31, 7
    s_lshl_b32 s45, s30, 2
    s_add_u32 s44, s44, s45
    v_bfe_u32 v20, v0, 4, 1
    v_lshl_add_u32 v21, v4, 1, v20
    v_lshlrev_b32 v22, 1, v21
    v_lshlrev_b32 v21, 2, v21
    v_lshlrev_b32 v7, 9, v3
    v_lshl_add_u32 v7, v4, 4, v7
    s_lshl_b32 s45, s30, 4
    s_add_u32 s48, s48, s45
    s_add_u32 s56, s48, 1310720
    s_add_u32 s57, s48, 1314816
    s_add_u32 s58, s48, 1318912
    s_add_u32 s59, s48, 1323008
    ds_read_b32 v17, v1 offset:3340
    s_and_b32 s63, s30, 7
    s_cmp_lg_u32 s63, 0
    s_cbranch_scc1 L_nob2
    buffer_load_ushort v37, v22, s[40:43], s44 offen
L_nob2:
    v_mov_b32 v52, 0
    v_mov_b32 v53, s47
    v_mov_b32 v54, 0
    v_mov_b32 v55, s47
    s_waitcnt lgkmcnt(0)
    v_readfirstlane_b32 s85, v17
    v_mfma_f32_16x16x32_bf16 v[8:11], v[104:107], v[72:75], 0
    v_mfma_f32_16x16x32_bf16 v[8:11], v[108:111], v[76:79], v[8:11]
    v_mfma_f32_16x16x32_bf16 v[8:11], v[112:115], v[80:83], v[8:11]
    v_mfma_f32_16x16x32_bf16 v[8:11], v[116:119], v[84:87], v[8:11]
    v_mfma_f32_16x16x32_bf16 v[8:11], v[120:123], v[88:91], v[8:11]
    v_mfma_f32_16x16x32_bf16 v[8:11], v[124:127], v[92:95], v[8:11]
    s_nop 7
    v_permlane32_swap_b32 v8, v10
    v_permlane32_swap_b32 v9, v11
    s_nop 0
    v_add_f32_dpp v8, v10, v8 row_ror:8 row_mask:0xf bank_mask:0xf
    v_add_f32_dpp v9, v11, v9 row_ror:8 row_mask:0xf bank_mask:0xf
    ds_bpermute_b32 v12, v6, v8
    ds_bpermute_b32 v14, v6, v9
    v_mov_b32 v13, s47
    v_mov_b32 v15, s47
    s_waitcnt lgkmcnt(0)
    s_cmp_eq_u32 s85, 1
    s_mov_b32 exec_hi, 0
    s_cbranch_scc0 L_mps_s
    buffer_store_dwordx4 v[12:15], v2, s[52:55], s49 offen
    s_branch L_mps_d
L_mps_s:
    buffer_store_dwordx4 v[12:15], v2, s[52:55], s49 offen sc1
L_mps_d:
    s_mov_b64 exec, -1
    s_cmp_lg_u32 s63, 0
    s_cbranch_scc1 L_fin
    s_mov_b32 s45, 0
L_m2g:
    ds_read_b32 v16, v1 offset:3332
    s_add_u32 s45, s45, 1
    s_waitcnt lgkmcnt(0)
    v_readfirstlane_b32 s44, v16
    s_nop 0
    s_cmp_ge_u32 s44, 4
    s_cbranch_scc1 L_m2g_ok
    s_sleep 2
    s_cmp_lt_u32 s45, 3200000
    s_cbranch_scc1 L_m2g
L_m2g_ok:
    buffer_load_dwordx4 v[40:43], v7, s[52:55], s56 offen sc1
    buffer_load_dwordx4 v[44:47], v7, s[52:55], s57 offen sc1
    buffer_load_dwordx4 v[48:51], v7, s[52:55], s58 offen sc1
    s_mov_b32 exec_hi, 0xff
    buffer_load_dwordx4 v[52:55], v7, s[52:55], s59 offen sc1
    s_mov_b64 exec, -1
    s_mov_b32 s45, 0
L_mp:
    s_waitcnt vmcnt(0)
    v_xor_b32 v16, s47, v41
    v_bitop3_b32 v16, v16, v43, s47 bitop3:0xf6
    v_bitop3_b32 v16, v16, v45, s47 bitop3:0xf6
    v_bitop3_b32 v16, v16, v47, s47 bitop3:0xf6
    v_bitop3_b32 v16, v16, v49, s47 bitop3:0xf6
    v_bitop3_b32 v16, v16, v51, s47 bitop3:0xf6
    v_bitop3_b32 v16, v16, v53, s47 bitop3:0xf6
    v_bitop3_b32 v16, v16, v55, s47 bitop3:0xf6
    v_cmp_ne_u32 vcc, 0, v16
    s_nop 0
    s_cbranch_vccz L_mp_ok0
    buffer_load_dwordx4 v[40:43], v7, s[52:55], s56 offen sc1
    buffer_load_dwordx4 v[44:47], v7, s[52:55], s57 offen sc1
    buffer_load_dwordx4 v[48:51], v7, s[52:55], s58 offen sc1
    s_mov_b32 exec_hi, 0xff
    buffer_load_dwordx4 v[52:55], v7, s[52:55], s59 offen sc1
    s_mov_b64 exec, -1
    s_add_u32 s45, s45, 1
    s_cmp_lt_u32 s45, 400000
    s_cbranch_scc1 L_mp
L_mp_ok0:
L_mp_done:
    v_add_f32 v8, v40, v44
    v_add_f32 v9, v42, v46
    v_add_f32 v10, v48, v52
    v_add_f32 v11, v50, v54
    v_add_f32 v8, v8, v10
    v_add_f32 v9, v9, v11
    s_nop 0
    v_add_f32_dpp v8, v8, v8 row_ror:8 row_mask:0xf bank_mask:0xf
    v_add_f32_dpp v9, v9, v9 row_ror:8 row_mask:0xf bank_mask:0xf
    s_nop 1
    v_permlane16_swap_b32 v8, v9
    v_add_f32 v8, v8, v9
    v_mov_b32 v9, v8
    s_nop 1
    v_permlane32_swap_b32 v8, v9
    v_add_f32 v38, v8, v9
    v_cvt_pk_bf16_f32 v38, v38, v38
    v_and_b32 v38, 0xffff0000, v38
    v_lshlrev_b32 v37, 16, v37
    v_add_f32 v38, v38, v37
    v_cvt_pk_bf16_f32 v38, v38, v38
    v_and_b32 v38, 0xffff0000, v38
    v_mul_f32 v17, 0xbfb8aa3b, v38
    v_exp_f32 v17, v17
    s_nop 0
    v_add_f32 v17, 1.0, v17
    v_rcp_f32 v17, v17
    s_nop 0
    v_mul_f32 v38, v38, v17
    v_cvt_pk_bf16_f32 v38, v38, v38
    v_and_b32 v38, 0xffff0000, v38
    ds_write_b32 v21, v38 offset:3712
    ds_write_b32 v1, v39 offset:3356
L_fin:
L_end:
    s_endpgm

    .fill 192, 4, 0xbf810000

.section .rodata,"a"
.p2align 6
.amdhsa_kernel recurrent_scan__sliding_block_cached__mixer_channel_mlp__decode_kernel
  .amdhsa_next_free_vgpr 168
  .amdhsa_next_free_sgpr 96
  .amdhsa_accum_offset 168
  .amdhsa_group_segment_fixed_size 0
  .amdhsa_kernarg_size 104
  .amdhsa_user_sgpr_count 2
  .amdhsa_user_sgpr_kernarg_segment_ptr 1
  .amdhsa_system_sgpr_workgroup_id_x 1
.end_amdhsa_kernel
```
